```python
import torch

def _softmax(x, axis=-1):
    return torch.softmax(x, dim=axis)
def _gelu(x):
    return torch.nn.functional.gelu(x, approximate="tanh")
def _silu(x):
    return torch.nn.functional.silu(x)
def _sigmoid(x):
    return torch.sigmoid(x)
def _layernorm(x, axis=-1, eps=1e-5):
    m = x.mean(dim=axis, keepdim=True)
    v = x.var(dim=axis, keepdim=True, unbiased=False)
    return (x - m) / torch.sqrt(v + eps)
def _scatter_add(tgt, idx, src, axis=0):
    return tgt.clone().index_add_(axis, idx, src)
def _segment_sum(src, seg, n):
    out = torch.zeros((n,) + src.shape[1:], dtype=src.dtype)
    return out.index_add_(0, seg, src)
def _pad(x, pw):
    flat = tuple(v for pair in reversed(pw) for v in pair)
    return torch.nn.functional.pad(x, flat)

kernel_name = 'recurrent_scan__softmax_full_mha__dense_activation_relu__prompt'

def setup_inputs():

    _w = (lambda a: (lambda t: t.to(torch.bfloat16) if t.is_floating_point() else t)(torch.as_tensor(a)))
    def _A_setup():
        B, S, D = 1, 2048, 512
        return {
            "x": _w((lambda *s: torch.randn(*s, dtype=torch.bfloat16) * 0.05)(B, S, D)),
            "wqkv": _w((lambda *s: torch.randn(*s, dtype=torch.bfloat16) * 0.05)(D, 3 * D)),
            "wo": _w((lambda *s: torch.randn(*s, dtype=torch.bfloat16) * 0.05)(D, D)),
        }
    _A_in = _A_setup()

    def _B_setup():
        B, S, D, Dff = 1, 2048, 512, 1376
        return {
            "x": _w((lambda *s: torch.randn(*s, dtype=torch.bfloat16) * 0.05)(B, S, D)),
            "w1": _w((lambda *s: torch.randn(*s, dtype=torch.bfloat16) * 0.05)(D, Dff)),
            "w2": _w((lambda *s: torch.randn(*s, dtype=torch.bfloat16) * 0.05)(Dff, D)),
        }
    _B_in = _B_setup()

    return {
        "A_x": _A_in["x"],
        "A_wqkv": _A_in["wqkv"],
        "A_wo": _A_in["wo"],
        "B_x": _B_in["x"],
        "B_w1": _B_in["w1"],
        "B_w2": _B_in["w2"],
    }

def reference(A_x, A_wqkv, A_wo, B_x, B_w1, B_w2):
    def _A_ref(x, wqkv, wo):
        B, S, D = x.shape
        H = 32; Dh = D // H
        qkv = (lambda x, *d: x.permute(*d))((x @ wqkv).reshape(B, S, 3, H, Dh), 2, 0, 3, 1, 4)
        q, k, v = qkv[0], qkv[1], qkv[2]
        scale = Dh ** -0.5
        scores = torch.einsum("bhqd,bhkd->bhqk", q, k) * scale
        p = _softmax(scores, axis=-1)
        o = torch.einsum("bhqk,bhkd->bhqd", p, v)
        return (lambda x, *d: x.permute(*d))(o, 0, 2, 1, 3).reshape(B, S, D) @ wo

    def _B_ref(x, w1, w2):
        h = torch.einsum("bsd,df->bsf", x, w1)
        zero = torch.zeros_like(h)
        h = torch.maximum(h, zero)
        return torch.einsum("bsf,fd->bsd", h, w2)

    x = A_x
    xn = _layernorm(x, axis=-1)
    s = _A_ref(xn, A_wqkv, A_wo)
    g = _silu(_B_ref(xn, B_w1, B_w2))
    return x + s * g
```

```asm
; @launch grid=(256,1,1) block=(512,1,1) lds=163840
.amdgcn_target "amdgcn-amd-amdhsa--gfx950"
.text
.globl recurrent_scan__softmax_full_mha__dense_activation_relu__prompt_kernel
.p2align 8
.type recurrent_scan__softmax_full_mha__dense_activation_relu__prompt_kernel,@function
recurrent_scan__softmax_full_mha__dense_activation_relu__prompt_kernel:
    s_load_dwordx2 s[4:5], s[0:1], 0
    s_cmp_ge_u32 s2, 256
    s_cbranch_scc1 L_exit
    s_setprio 3
    s_load_dwordx16 s[64:79], s[0:1], 0
    s_load_dwordx2 s[80:81], s[0:1], 64
    s_lshl_b32 s54, s2, 3
    s_and_b32 s54, s54, 24
    s_bfe_u32 s55, s2, 0x30003
    s_or_b32 s25, s54, s55
    s_and_b32 s54, s2, 4
    s_lshr_b32 s55, s2, 6
    s_or_b32 s26, s54, s55
    s_add_u32 s27, s25, s26
    s_and_b32 s90, s27, 3
    s_add_u32 s27, s27, 1
    s_and_b32 s91, s27, 3
    v_lshrrev_b32 v13, 3, v0
    v_and_b32 v14, 7, v0
    v_lshlrev_b32 v27, 4, v14
    v_lshl_add_u32 v27, v13, 10, v27
    s_lshl_b32 s52, s25, 16
    v_add_u32 v27, s52, v27
    s_mov_b32 s6, 0x200000
    s_mov_b32 s7, 0x00020000
    s_waitcnt lgkmcnt(0)
    s_lshl_b32 s54, s90, 8
    buffer_load_dwordx4 v[128:131], v27, s[4:7], s54 offen
    buffer_load_dwordx4 v[132:135], v27, s[4:7], s54 offen offset:128
    s_lshl_b32 s54, s91, 8
    buffer_load_dwordx4 v[136:139], v27, s[4:7], s54 offen
    buffer_load_dwordx4 v[140:143], v27, s[4:7], s54 offen offset:128
    s_setprio 2
    s_load_dword s28, s[80:81], 0
    s_getpc_b64 s[88:89]
L_pc:
    s_bfe_u32 s3, s2, 0x30003
    s_mul_i32 s3, s3, 3
    v_lshrrev_b32 v30, 6, v0
    v_mul_u32_u24 v28, 24, v30
    v_and_b32 v29, 3, v0
    v_add3_u32 v28, v28, v29, s3
    v_lshlrev_b32 v28, 7, v28
    v_min_u32 v28, L_codeend-L_pc-4, v28
    s_mov_b64 exec, 7
    global_load_dword v29, v28, s[88:89]
    s_mov_b64 exec, -1
    v_readfirstlane_b32 s24, v30
    v_and_b32 v1, 63, v0
    v_lshlrev_b32 v2, 4, v1
    s_xor_b32 s92, s90, 2
    s_xor_b32 s93, s91, 2
    s_mov_b32 s8, s66
    s_mov_b32 s9, s67
    s_mov_b32 s10, 0x180000
    s_mov_b32 s11, 0x00020000
    v_bfe_u32 v24, v0, 4, 3
    v_xor_b32 v24, v24, v14
    v_lshlrev_b32 v24, 4, v24
    v_lshl_add_u32 v24, v13, 7, v24
    v_add_u32 v25, 131072, v24
    v_lshrrev_b32 v26, 3, v1
    v_bfe_u32 v13, v1, 4, 1
    v_lshlrev_b32 v13, 2, v13
    v_xor_b32 v127, v14, v13
    v_lshlrev_b32 v127, 4, v127
    v_mul_u32_u24 v4, 3072, v26
    v_add_u32 v4, v4, v127
    v_add_u32 v5, 23552, v4
    v_lshl_add_u32 v127, v26, 10, v127
    s_lshr_b32 s58, s24, 2
    s_and_b32 s63, s24, 3
    s_and_b32 s32, s24, 1
    s_mul_i32 s33, s63, 49152
    s_lshl_b32 s54, s26, 7
    s_add_u32 s33, s33, s54
    s_mul_i32 s55, s54, 3
    s_mul_i32 s37, s63, 44032
    s_add_u32 s37, s37, s55
    s_mul_i32 s36, s24, 24576
    s_add_u32 s36, s36, s54
    s_mov_b32 s96, s72
    s_mov_b32 s97, s73
    s_mov_b32 s98, 0x158000
    s_mov_b32 s99, 0x00020000
    s_mul_i32 s31, s24, 3072
    s_add_u32 s31, s31, 32768
    s_mul_i32 s39, s63, 6144
    s_add_u32 s39, s39, 32768
    s_lshl_b32 s34, s58, 10
    s_add_u32 s34, s34, s33
    s_add_u32 s34, s34, 1024
    s_mov_b32 s46, 0x3f803f80
    s_mov_b32 s12, s80
    s_mov_b32 s13, s81
    s_mov_b32 s14, 17825792
    s_mov_b32 s15, 0x00020000
    s_bfe_u32 s53, s24, 0x10001
    s_lshl_b32 s55, s26, 1
    s_add_u32 s55, s55, s53
    s_lshl_b32 s56, s55, 19
    s_lshr_b32 s55, s25, 1
    s_lshl_b32 s55, s55, 2
    s_and_b32 s52, s25, 1
    s_add_u32 s55, s55, s52
    s_lshl_b32 s55, s55, 1
    s_add_u32 s55, s55, s32
    s_lshl_b32 s55, s55, 11
    s_add_u32 s56, s56, s55
    s_add_u32 s56, s56, 1048576
    s_mul_i32 s55, s26, 6
    s_add_u32 s55, s55, s53
    s_lshl_b32 s57, s55, 12
    s_lshl_b32 s55, s32, 10
    s_add_u32 s57, s57, s55
    s_lshl_b32 s30, s26, 12
    s_lshl_b32 s55, s25, 7
    s_add_u32 s35, s30, s55
    s_add_u32 s30, s30, 32768
    s_lshl_b32 s52, s25, 12
    s_lshl_b32 s55, s63, 7
    s_add_u32 s52, s52, s55
    s_lshl_b32 s55, s26, 9
    s_add_u32 s29, s52, s55
    v_and_b32 v13, 31, v1
    v_bfe_u32 v14, v1, 1, 3
    v_lshrrev_b32 v12, 5, v1
    v_xor_b32 v112, v12, v14
    v_lshlrev_b32 v112, 4, v112
    v_lshl_add_u32 v112, v13, 7, v112
    s_lshl_b32 s55, s32, 12
    s_add_u32 s55, s55, 131072
    v_add_u32 v112, s55, v112
    v_xor_b32 v113, 32, v112
    v_xor_b32 v114, 64, v112
    v_xor_b32 v115, 0x60, v112
    v_bfe_u32 v10, v1, 4, 1
    v_and_b32 v14, 3, v1
    v_lshlrev_b32 v121, 3, v14
    v_lshl_add_u32 v121, v10, 5, v121
    v_bfe_u32 v13, v1, 3, 1
    v_lshl_add_u32 v11, v13, 6, v121
    v_bfe_u32 v13, v1, 2, 2
    v_lshl_add_u32 v120, v12, 3, v13
    v_lshl_add_u32 v8, v13, 7, v11
    s_lshl_b32 s55, s53, 6
    v_xor_b32 v8, s55, v8
    v_mul_u32_u24 v9, 3072, v12
    v_add_u32 v8, v8, v9
    v_add_u32 v8, 32768, v8
    v_add_u32 v9, 49152, v8
    v_mul_u32_u24 v120, 384, v120
    s_lshl_b32 s55, s53, 6
    v_xor_b32 v121, s55, v11
    v_add_u32 v120, v120, v121
    v_add_u32 v120, 32768, v120
    v_add_u32 v121, 0x10000, v120
    v_lshl_add_u32 v124, v12, 2, v13
    v_lshl_add_u32 v124, v124, 7, v11
    v_and_b32 v14, 15, v1
    v_lshlrev_b32 v3, 4, v14
    v_lshl_add_u32 v3, v12, 8, v3
    v_add_u32 v3, 1024, v3
    v_lshl_add_u32 v10, v10, 18, v3
    v_mov_b64 v[16:17], 0
    v_mov_b64 v[18:19], 0
    s_mov_b32 s55, 0xffff0000
    s_lshl_b32 s54, s92, 8
    buffer_load_dwordx4 v[144:147], v27, s[4:7], s54 offen
    buffer_load_dwordx4 v[148:151], v27, s[4:7], s54 offen offset:128
    s_lshl_b32 s54, s93, 8
    buffer_load_dwordx4 v[152:155], v27, s[4:7], s54 offen
    buffer_load_dwordx4 v[156:159], v27, s[4:7], s54 offen offset:128
    s_setprio 0
    s_waitcnt vmcnt(8)
    v_dot2c_f32_bf16 v16, s46, v128
    v_dot2c_f32_bf16 v18, v128, v128
    v_dot2c_f32_bf16 v17, s46, v129
    v_dot2c_f32_bf16 v19, v129, v129
    v_dot2c_f32_bf16 v16, s46, v130
    v_dot2c_f32_bf16 v18, v130, v130
    v_dot2c_f32_bf16 v17, s46, v131
    v_dot2c_f32_bf16 v19, v131, v131
    v_lshlrev_b32 v160, 16, v128
    v_and_b32 v161, s55, v128
    v_lshlrev_b32 v162, 16, v129
    v_and_b32 v163, s55, v129
    v_lshlrev_b32 v164, 16, v130
    v_and_b32 v165, s55, v130
    v_lshlrev_b32 v166, 16, v131
    v_and_b32 v167, s55, v131
    s_waitcnt vmcnt(7)
    v_dot2c_f32_bf16 v16, s46, v132
    v_dot2c_f32_bf16 v18, v132, v132
    v_dot2c_f32_bf16 v17, s46, v133
    v_dot2c_f32_bf16 v19, v133, v133
    v_dot2c_f32_bf16 v16, s46, v134
    v_dot2c_f32_bf16 v18, v134, v134
    v_dot2c_f32_bf16 v17, s46, v135
    v_dot2c_f32_bf16 v19, v135, v135
    v_lshlrev_b32 v168, 16, v132
    v_and_b32 v169, s55, v132
    v_lshlrev_b32 v170, 16, v133
    v_and_b32 v171, s55, v133
    v_lshlrev_b32 v172, 16, v134
    v_and_b32 v173, s55, v134
    v_lshlrev_b32 v174, 16, v135
    v_and_b32 v175, s55, v135
    s_waitcnt vmcnt(6)
    v_dot2c_f32_bf16 v16, s46, v136
    v_dot2c_f32_bf16 v18, v136, v136
    v_dot2c_f32_bf16 v17, s46, v137
    v_dot2c_f32_bf16 v19, v137, v137
    v_dot2c_f32_bf16 v16, s46, v138
    v_dot2c_f32_bf16 v18, v138, v138
    v_dot2c_f32_bf16 v17, s46, v139
    v_dot2c_f32_bf16 v19, v139, v139
    v_lshlrev_b32 v176, 16, v136
    v_and_b32 v177, s55, v136
    v_lshlrev_b32 v178, 16, v137
    v_and_b32 v179, s55, v137
    v_lshlrev_b32 v180, 16, v138
    v_and_b32 v181, s55, v138
    v_lshlrev_b32 v182, 16, v139
    v_and_b32 v183, s55, v139
    s_waitcnt vmcnt(5)
    v_dot2c_f32_bf16 v16, s46, v140
    v_dot2c_f32_bf16 v18, v140, v140
    v_dot2c_f32_bf16 v17, s46, v141
    v_dot2c_f32_bf16 v19, v141, v141
    v_dot2c_f32_bf16 v16, s46, v142
    v_dot2c_f32_bf16 v18, v142, v142
    v_dot2c_f32_bf16 v17, s46, v143
    v_dot2c_f32_bf16 v19, v143, v143
    v_lshlrev_b32 v184, 16, v140
    v_and_b32 v185, s55, v140
    v_lshlrev_b32 v186, 16, v141
    v_and_b32 v187, s55, v141
    v_lshlrev_b32 v188, 16, v142
    v_and_b32 v189, s55, v142
    v_lshlrev_b32 v190, 16, v143
    v_and_b32 v191, s55, v143
    s_mul_i32 s54, s90, 393216
    s_add_u32 m0, s31, 0
    s_add_u32 s54, s54, s36
    buffer_load_dwordx4 v4, s[8:11], s54 offen lds
    buffer_load_dwordx4 v4, s[8:11], s54 offen offset:1024 lds
    buffer_load_dwordx4 v4, s[8:11], s54 offen offset:2048 lds
    s_waitcnt vmcnt(6)
    v_dot2c_f32_bf16 v16, s46, v144
    v_dot2c_f32_bf16 v18, v144, v144
    v_dot2c_f32_bf16 v17, s46, v145
    v_dot2c_f32_bf16 v19, v145, v145
    v_dot2c_f32_bf16 v16, s46, v146
    v_dot2c_f32_bf16 v18, v146, v146
    v_dot2c_f32_bf16 v17, s46, v147
    v_dot2c_f32_bf16 v19, v147, v147
    s_waitcnt vmcnt(5)
    v_dot2c_f32_bf16 v16, s46, v148
    v_dot2c_f32_bf16 v18, v148, v148
    v_dot2c_f32_bf16 v17, s46, v149
    v_dot2c_f32_bf16 v19, v149, v149
    v_dot2c_f32_bf16 v16, s46, v150
    v_dot2c_f32_bf16 v18, v150, v150
    v_dot2c_f32_bf16 v17, s46, v151
    v_dot2c_f32_bf16 v19, v151, v151
    s_waitcnt vmcnt(4)
    v_dot2c_f32_bf16 v16, s46, v152
    v_dot2c_f32_bf16 v18, v152, v152
    v_dot2c_f32_bf16 v17, s46, v153
    v_dot2c_f32_bf16 v19, v153, v153
    v_dot2c_f32_bf16 v16, s46, v154
    v_dot2c_f32_bf16 v18, v154, v154
    v_dot2c_f32_bf16 v17, s46, v155
    v_dot2c_f32_bf16 v19, v155, v155
    s_waitcnt vmcnt(3)
    v_dot2c_f32_bf16 v16, s46, v156
    v_dot2c_f32_bf16 v18, v156, v156
    v_dot2c_f32_bf16 v17, s46, v157
    v_dot2c_f32_bf16 v19, v157, v157
    v_dot2c_f32_bf16 v16, s46, v158
    v_dot2c_f32_bf16 v18, v158, v158
    v_dot2c_f32_bf16 v17, s46, v159
    v_dot2c_f32_bf16 v19, v159, v159
    s_nop 2
    v_add_f32 v16, v16, v17
    v_add_f32 v18, v18, v19
    s_nop 1
    v_add_f32_dpp v16, v16, v16 quad_perm:[1,0,3,2] row_mask:0xf bank_mask:0xf
    v_add_f32_dpp v18, v18, v18 quad_perm:[1,0,3,2] row_mask:0xf bank_mask:0xf
    s_nop 1
    v_add_f32_dpp v16, v16, v16 quad_perm:[2,3,0,1] row_mask:0xf bank_mask:0xf
    v_add_f32_dpp v18, v18, v18 quad_perm:[2,3,0,1] row_mask:0xf bank_mask:0xf
    s_nop 1
    v_add_f32_dpp v16, v16, v16 row_half_mirror row_mask:0xf bank_mask:0xf
    v_add_f32_dpp v18, v18, v18 row_half_mirror row_mask:0xf bank_mask:0xf
    v_mul_f32 v22, 0xbb000000, v16
    v_mul_f32 v18, 0x3b000000, v18
    v_fma_f32 v18, -v22, v22, v18
    v_max_f32 v18, 0, v18
    v_add_f32 v18, 0x3727c5ac, v18
    v_rsq_f32 v20, v18
    s_waitcnt lgkmcnt(0)
    v_mul_f32 v22, v22, v20
    s_mul_i32 s28, s28, 0x9E3779B1
    s_add_u32 s28, s28, 0x7F4A7C15
    v_pk_fma_f32 v[160:161], v[160:161], v[20:21], v[22:23] op_sel_hi:[1,0,0]
    v_pk_fma_f32 v[162:163], v[162:163], v[20:21], v[22:23] op_sel_hi:[1,0,0]
    v_pk_fma_f32 v[164:165], v[164:165], v[20:21], v[22:23] op_sel_hi:[1,0,0]
    v_pk_fma_f32 v[166:167], v[166:167], v[20:21], v[22:23] op_sel_hi:[1,0,0]
    v_cvt_pk_bf16_f32 v128, v160, v161
    v_cvt_pk_bf16_f32 v129, v162, v163
    v_cvt_pk_bf16_f32 v130, v164, v165
    v_cvt_pk_bf16_f32 v131, v166, v167
    ds_write_b128 v25, v[128:131] offset:0
    v_pk_fma_f32 v[168:169], v[168:169], v[20:21], v[22:23] op_sel_hi:[1,0,0]
    v_pk_fma_f32 v[170:171], v[170:171], v[20:21], v[22:23] op_sel_hi:[1,0,0]
    v_pk_fma_f32 v[172:173], v[172:173], v[20:21], v[22:23] op_sel_hi:[1,0,0]
    v_pk_fma_f32 v[174:175], v[174:175], v[20:21], v[22:23] op_sel_hi:[1,0,0]
    v_cvt_pk_bf16_f32 v132, v168, v169
    v_cvt_pk_bf16_f32 v133, v170, v171
    v_cvt_pk_bf16_f32 v134, v172, v173
    v_cvt_pk_bf16_f32 v135, v174, v175
    ds_write_b128 v25, v[132:135] offset:8192
    v_pk_fma_f32 v[176:177], v[176:177], v[20:21], v[22:23] op_sel_hi:[1,0,0]
    v_pk_fma_f32 v[178:179], v[178:179], v[20:21], v[22:23] op_sel_hi:[1,0,0]
    v_pk_fma_f32 v[180:181], v[180:181], v[20:21], v[22:23] op_sel_hi:[1,0,0]
    v_pk_fma_f32 v[182:183], v[182:183], v[20:21], v[22:23] op_sel_hi:[1,0,0]
    v_cvt_pk_bf16_f32 v136, v176, v177
    v_cvt_pk_bf16_f32 v137, v178, v179
    v_cvt_pk_bf16_f32 v138, v180, v181
    v_cvt_pk_bf16_f32 v139, v182, v183
    ds_write_b128 v25, v[136:139] offset:16384
    v_pk_fma_f32 v[184:185], v[184:185], v[20:21], v[22:23] op_sel_hi:[1,0,0]
    v_pk_fma_f32 v[186:187], v[186:187], v[20:21], v[22:23] op_sel_hi:[1,0,0]
    v_pk_fma_f32 v[188:189], v[188:189], v[20:21], v[22:23] op_sel_hi:[1,0,0]
    v_pk_fma_f32 v[190:191], v[190:191], v[20:21], v[22:23] op_sel_hi:[1,0,0]
    v_cvt_pk_bf16_f32 v140, v184, v185
    v_cvt_pk_bf16_f32 v141, v186, v187
    v_cvt_pk_bf16_f32 v142, v188, v189
    v_cvt_pk_bf16_f32 v143, v190, v191
    ds_write_b128 v25, v[140:143] offset:24576
    v_lshlrev_b32 v192, 16, v144
    v_and_b32 v193, s55, v144
    v_lshlrev_b32 v194, 16, v145
    v_and_b32 v195, s55, v145
    v_lshlrev_b32 v196, 16, v146
    v_and_b32 v197, s55, v146
    v_lshlrev_b32 v198, 16, v147
    v_and_b32 v199, s55, v147
    v_pk_fma_f32 v[192:193], v[192:193], v[20:21], v[22:23] op_sel_hi:[1,0,0]
    v_pk_fma_f32 v[194:195], v[194:195], v[20:21], v[22:23] op_sel_hi:[1,0,0]
    v_pk_fma_f32 v[196:197], v[196:197], v[20:21], v[22:23] op_sel_hi:[1,0,0]
    v_pk_fma_f32 v[198:199], v[198:199], v[20:21], v[22:23] op_sel_hi:[1,0,0]
    v_cvt_pk_bf16_f32 v144, v192, v193
    v_cvt_pk_bf16_f32 v145, v194, v195
    v_cvt_pk_bf16_f32 v146, v196, v197
    v_cvt_pk_bf16_f32 v147, v198, v199
    ds_write_b128 v24, v[144:147] offset:0
    v_lshlrev_b32 v200, 16, v148
    v_and_b32 v201, s55, v148
    v_lshlrev_b32 v202, 16, v149
    v_and_b32 v203, s55, v149
    v_lshlrev_b32 v204, 16, v150
    v_and_b32 v205, s55, v150
    v_lshlrev_b32 v206, 16, v151
    v_and_b32 v207, s55, v151
    v_pk_fma_f32 v[200:201], v[200:201], v[20:21], v[22:23] op_sel_hi:[1,0,0]
    v_pk_fma_f32 v[202:203], v[202:203], v[20:21], v[22:23] op_sel_hi:[1,0,0]
    v_pk_fma_f32 v[204:205], v[204:205], v[20:21], v[22:23] op_sel_hi:[1,0,0]
    v_pk_fma_f32 v[206:207], v[206:207], v[20:21], v[22:23] op_sel_hi:[1,0,0]
    v_cvt_pk_bf16_f32 v148, v200, v201
    v_cvt_pk_bf16_f32 v149, v202, v203
    v_cvt_pk_bf16_f32 v150, v204, v205
    v_cvt_pk_bf16_f32 v151, v206, v207
    ds_write_b128 v24, v[148:151] offset:8192
    v_lshlrev_b32 v208, 16, v152
    v_and_b32 v209, s55, v152
    v_lshlrev_b32 v210, 16, v153
    v_and_b32 v211, s55, v153
    v_lshlrev_b32 v212, 16, v154
    v_and_b32 v213, s55, v154
    v_lshlrev_b32 v214, 16, v155
    v_and_b32 v215, s55, v155
    v_pk_fma_f32 v[208:209], v[208:209], v[20:21], v[22:23] op_sel_hi:[1,0,0]
    v_pk_fma_f32 v[210:211], v[210:211], v[20:21], v[22:23] op_sel_hi:[1,0,0]
    v_pk_fma_f32 v[212:213], v[212:213], v[20:21], v[22:23] op_sel_hi:[1,0,0]
    v_pk_fma_f32 v[214:215], v[214:215], v[20:21], v[22:23] op_sel_hi:[1,0,0]
    v_cvt_pk_bf16_f32 v152, v208, v209
    v_cvt_pk_bf16_f32 v153, v210, v211
    v_cvt_pk_bf16_f32 v154, v212, v213
    v_cvt_pk_bf16_f32 v155, v214, v215
    ds_write_b128 v24, v[152:155] offset:16384
    v_lshlrev_b32 v216, 16, v156
    v_and_b32 v217, s55, v156
    v_lshlrev_b32 v218, 16, v157
    v_and_b32 v219, s55, v157
    v_lshlrev_b32 v220, 16, v158
    v_and_b32 v221, s55, v158
    v_lshlrev_b32 v222, 16, v159
    v_and_b32 v223, s55, v159
    v_pk_fma_f32 v[216:217], v[216:217], v[20:21], v[22:23] op_sel_hi:[1,0,0]
    v_pk_fma_f32 v[218:219], v[218:219], v[20:21], v[22:23] op_sel_hi:[1,0,0]
    v_pk_fma_f32 v[220:221], v[220:221], v[20:21], v[22:23] op_sel_hi:[1,0,0]
    v_pk_fma_f32 v[222:223], v[222:223], v[20:21], v[22:23] op_sel_hi:[1,0,0]
    v_cvt_pk_bf16_f32 v156, v216, v217
    v_cvt_pk_bf16_f32 v157, v218, v219
    v_cvt_pk_bf16_f32 v158, v220, v221
    v_cvt_pk_bf16_f32 v159, v222, v223
    ds_write_b128 v24, v[156:159] offset:24576
    s_mul_i32 s54, s90, 393216
    s_add_u32 m0, s31, 24576
    s_add_u32 s54, s54, s36
    s_add_u32 s54, s54, 196608
    buffer_load_dwordx4 v4, s[8:11], s54 offen lds
    buffer_load_dwordx4 v4, s[8:11], s54 offen offset:1024 lds
    buffer_load_dwordx4 v4, s[8:11], s54 offen offset:2048 lds
    s_cmp_lg_u32 s58, 0
    s_cbranch_scc1 L_fwave
    s_waitcnt vmcnt(3)
    s_waitcnt lgkmcnt(0)
    s_barrier
    ds_read_b64_tr_b16 v[32:33], v8 offset:1024
    ds_read_b64_tr_b16 v[34:35], v8 offset:1536
    s_mul_i32 s54, s91, 393216
    s_add_u32 m0, s31, 49152
    s_add_u32 s54, s54, s36
    buffer_load_dwordx4 v4, s[8:11], s54 offen lds
    ds_read_b128 v[128:131], v112 offset:0
    ds_read_b64_tr_b16 v[36:37], v8 offset:0
    ds_read_b64_tr_b16 v[38:39], v8 offset:512
    buffer_load_dwordx4 v4, s[8:11], s54 offen offset:1024 lds
    ds_read_b64_tr_b16 v[40:41], v8 offset:7168
    ds_read_b64_tr_b16 v[42:43], v8 offset:7680
    buffer_load_dwordx4 v4, s[8:11], s54 offen offset:2048 lds
    ds_read_b128 v[132:135], v113 offset:0
    ds_read_b64_tr_b16 v[44:45], v8 offset:6144
    ds_read_b64_tr_b16 v[46:47], v8 offset:6656
    ds_read_b64_tr_b16 v[48:49], v8 offset:13312
    ds_read_b64_tr_b16 v[50:51], v8 offset:13824
    s_mul_i32 s54, s91, 393216
    s_add_u32 m0, s31, 73728
    s_add_u32 s54, s54, s36
    s_add_u32 s54, s54, 196608
    buffer_load_dwordx4 v4, s[8:11], s54 offen lds
    ds_read_b128 v[136:139], v114 offset:0
    ds_read_b64_tr_b16 v[52:53], v8 offset:12288
    ds_read_b64_tr_b16 v[54:55], v8 offset:12800
    ds_read_b64_tr_b16 v[56:57], v8 offset:19456
    ds_read_b64_tr_b16 v[58:59], v8 offset:19968
    buffer_load_dwordx4 v4, s[8:11], s54 offen offset:1024 lds
    ds_read_b128 v[140:143], v115 offset:0
    ds_read_b64_tr_b16 v[60:61], v8 offset:18432
    ds_read_b64_tr_b16 v[62:63], v8 offset:18944
    buffer_load_dwordx4 v4, s[8:11], s54 offen offset:2048 lds
    s_waitcnt vmcnt(6)
    s_waitcnt lgkmcnt(0)
    s_barrier
    v_mfma_f32_32x32x16_bf16 v[16:31], v[32:35], v[128:131], 0
    ds_read_b64_tr_b16 v[64:65], v8 offset:25600
    ds_read_b64_tr_b16 v[66:67], v8 offset:26112
    s_mul_i32 s54, s92, 393216
    s_add_u32 m0, s31, 0
    s_add_u32 s54, s54, s36
    buffer_load_dwordx4 v4, s[8:11], s54 offen lds
    v_mfma_f32_32x32x16_bf16 v[96:111], v[36:39], v[128:131], 0
    ds_read_b128 v[144:147], v112 offset:8192
    ds_read_b64_tr_b16 v[68:69], v8 offset:24576
    ds_read_b64_tr_b16 v[70:71], v8 offset:25088
    v_mfma_f32_32x32x16_bf16 v[16:31], v[40:43], v[132:135], v[16:31]
    ds_read_b64_tr_b16 v[72:73], v8 offset:31744
    ds_read_b64_tr_b16 v[74:75], v8 offset:32256
    buffer_load_dwordx4 v4, s[8:11], s54 offen offset:1024 lds
    v_mfma_f32_32x32x16_bf16 v[96:111], v[44:47], v[132:135], v[96:111]
    ds_read_b128 v[148:151], v113 offset:8192
    ds_read_b64_tr_b16 v[76:77], v8 offset:30720
    ds_read_b64_tr_b16 v[78:79], v8 offset:31232
    v_mfma_f32_32x32x16_bf16 v[16:31], v[48:51], v[136:139], v[16:31]
    ds_read_b64_tr_b16 v[80:81], v8 offset:37888
    ds_read_b64_tr_b16 v[82:83], v8 offset:38400
    buffer_load_dwordx4 v4, s[8:11], s54 offen offset:2048 lds
    v_mfma_f32_32x32x16_bf16 v[96:111], v[52:55], v[136:139], v[96:111]
    ds_read_b128 v[152:155], v114 offset:8192
    ds_read_b64_tr_b16 v[84:85], v8 offset:36864
    ds_read_b64_tr_b16 v[86:87], v8 offset:37376
    v_mfma_f32_32x32x16_bf16 v[16:31], v[56:59], v[140:143], v[16:31]
    ds_read_b64_tr_b16 v[88:89], v8 offset:44032
    ds_read_b64_tr_b16 v[90:91], v8 offset:44544
    v_mfma_f32_32x32x16_bf16 v[96:111], v[60:63], v[140:143], v[96:111]
    ds_read_b128 v[156:159], v115 offset:8192
    ds_read_b64_tr_b16 v[92:93], v8 offset:43008
    ds_read_b64_tr_b16 v[94:95], v8 offset:43520
    s_waitcnt vmcnt(6)
    s_waitcnt lgkmcnt(0)
    s_barrier
    v_mfma_f32_32x32x16_bf16 v[16:31], v[64:67], v[144:147], v[16:31]
    ds_read_b64_tr_b16 v[32:33], v9 offset:1024
    ds_read_b64_tr_b16 v[34:35], v9 offset:1536
    s_mul_i32 s54, s92, 393216
    s_add_u32 m0, s31, 24576
    s_add_u32 s54, s54, s36
    s_add_u32 s54, s54, 196608
    buffer_load_dwordx4 v4, s[8:11], s54 offen lds
    v_mfma_f32_32x32x16_bf16 v[96:111], v[68:71], v[144:147], v[96:111]
    ds_read_b128 v[160:163], v112 offset:16384
    ds_read_b64_tr_b16 v[36:37], v9 offset:0
    ds_read_b64_tr_b16 v[38:39], v9 offset:512
    v_mfma_f32_32x32x16_bf16 v[16:31], v[72:75], v[148:151], v[16:31]
    ds_read_b64_tr_b16 v[40:41], v9 offset:7168
    ds_read_b64_tr_b16 v[42:43], v9 offset:7680
    buffer_load_dwordx4 v4, s[8:11], s54 offen offset:1024 lds
    v_mfma_f32_32x32x16_bf16 v[96:111], v[76:79], v[148:151], v[96:111]
    ds_read_b128 v[164:167], v113 offset:16384
    ds_read_b64_tr_b16 v[44:45], v9 offset:6144
    ds_read_b64_tr_b16 v[46:47], v9 offset:6656
    v_mfma_f32_32x32x16_bf16 v[16:31], v[80:83], v[152:155], v[16:31]
    ds_read_b64_tr_b16 v[48:49], v9 offset:13312
    ds_read_b64_tr_b16 v[50:51], v9 offset:13824
    buffer_load_dwordx4 v4, s[8:11], s54 offen offset:2048 lds
    v_mfma_f32_32x32x16_bf16 v[96:111], v[84:87], v[152:155], v[96:111]
    ds_read_b128 v[168:171], v114 offset:16384
    ds_read_b64_tr_b16 v[52:53], v9 offset:12288
    ds_read_b64_tr_b16 v[54:55], v9 offset:12800
    v_mfma_f32_32x32x16_bf16 v[16:31], v[88:91], v[156:159], v[16:31]
    ds_read_b64_tr_b16 v[56:57], v9 offset:19456
    ds_read_b64_tr_b16 v[58:59], v9 offset:19968
    v_mfma_f32_32x32x16_bf16 v[96:111], v[92:95], v[156:159], v[96:111]
    ds_read_b128 v[172:175], v115 offset:16384
    ds_read_b64_tr_b16 v[60:61], v9 offset:18432
    ds_read_b64_tr_b16 v[62:63], v9 offset:18944
    s_waitcnt vmcnt(6)
    s_waitcnt lgkmcnt(0)
    s_barrier
    v_mfma_f32_32x32x16_bf16 v[16:31], v[32:35], v[160:163], v[16:31]
    ds_read_b64_tr_b16 v[64:65], v9 offset:25600
    ds_read_b64_tr_b16 v[66:67], v9 offset:26112
    s_mul_i32 s54, s93, 393216
    s_add_u32 m0, s31, 49152
    s_add_u32 s54, s54, s36
    buffer_load_dwordx4 v4, s[8:11], s54 offen lds
    v_mfma_f32_32x32x16_bf16 v[96:111], v[36:39], v[160:163], v[96:111]
    ds_read_b128 v[176:179], v112 offset:24576
    ds_read_b64_tr_b16 v[68:69], v9 offset:24576
    ds_read_b64_tr_b16 v[70:71], v9 offset:25088
    v_mfma_f32_32x32x16_bf16 v[16:31], v[40:43], v[164:167], v[16:31]
    ds_read_b64_tr_b16 v[72:73], v9 offset:31744
    ds_read_b64_tr_b16 v[74:75], v9 offset:32256
    buffer_load_dwordx4 v4, s[8:11], s54 offen offset:1024 lds
    v_mfma_f32_32x32x16_bf16 v[96:111], v[44:47], v[164:167], v[96:111]
    ds_read_b128 v[180:183], v113 offset:24576
    ds_read_b64_tr_b16 v[76:77], v9 offset:30720
    ds_read_b64_tr_b16 v[78:79], v9 offset:31232
    v_mfma_f32_32x32x16_bf16 v[16:31], v[48:51], v[168:171], v[16:31]
    ds_read_b64_tr_b16 v[80:81], v9 offset:37888
    ds_read_b64_tr_b16 v[82:83], v9 offset:38400
    buffer_load_dwordx4 v4, s[8:11], s54 offen offset:2048 lds
    v_mfma_f32_32x32x16_bf16 v[96:111], v[52:55], v[168:171], v[96:111]
    ds_read_b128 v[184:187], v114 offset:24576
    ds_read_b64_tr_b16 v[84:85], v9 offset:36864
    ds_read_b64_tr_b16 v[86:87], v9 offset:37376
    v_mfma_f32_32x32x16_bf16 v[16:31], v[56:59], v[172:175], v[16:31]
    ds_read_b64_tr_b16 v[88:89], v9 offset:44032
    ds_read_b64_tr_b16 v[90:91], v9 offset:44544
    v_mfma_f32_32x32x16_bf16 v[96:111], v[60:63], v[172:175], v[96:111]
    ds_read_b128 v[188:191], v115 offset:24576
    ds_read_b64_tr_b16 v[92:93], v9 offset:43008
    ds_read_b64_tr_b16 v[94:95], v9 offset:43520
    v_subrev_u32 v112, 131072, v112
    v_subrev_u32 v113, 131072, v113
    v_subrev_u32 v114, 131072, v114
    v_subrev_u32 v115, 131072, v115
    s_waitcnt vmcnt(6)
    s_waitcnt lgkmcnt(0)
    s_barrier
    v_mfma_f32_32x32x16_bf16 v[16:31], v[64:67], v[176:179], v[16:31]
    ds_read_b64_tr_b16 v[32:33], v8 offset:1024
    ds_read_b64_tr_b16 v[34:35], v8 offset:1536
    s_mul_i32 s54, s93, 393216
    s_add_u32 m0, s31, 73728
    s_add_u32 s54, s54, s36
    s_add_u32 s54, s54, 196608
    buffer_load_dwordx4 v4, s[8:11], s54 offen lds
    v_mfma_f32_32x32x16_bf16 v[96:111], v[68:71], v[176:179], v[96:111]
    ds_read_b128 v[192:195], v112 offset:0
    ds_read_b64_tr_b16 v[36:37], v8 offset:0
    ds_read_b64_tr_b16 v[38:39], v8 offset:512
    v_mfma_f32_32x32x16_bf16 v[16:31], v[72:75], v[180:183], v[16:31]
    ds_read_b64_tr_b16 v[40:41], v8 offset:7168
    ds_read_b64_tr_b16 v[42:43], v8 offset:7680
    buffer_load_dwordx4 v4, s[8:11], s54 offen offset:1024 lds
    v_mfma_f32_32x32x16_bf16 v[96:111], v[76:79], v[180:183], v[96:111]
    ds_read_b128 v[196:199], v113 offset:0
    ds_read_b64_tr_b16 v[44:45], v8 offset:6144
    ds_read_b64_tr_b16 v[46:47], v8 offset:6656
    v_mfma_f32_32x32x16_bf16 v[16:31], v[80:83], v[184:187], v[16:31]
    ds_read_b64_tr_b16 v[48:49], v8 offset:13312
    ds_read_b64_tr_b16 v[50:51], v8 offset:13824
    buffer_load_dwordx4 v4, s[8:11], s54 offen offset:2048 lds
    v_mfma_f32_32x32x16_bf16 v[96:111], v[84:87], v[184:187], v[96:111]
    ds_read_b128 v[200:203], v114 offset:0
    ds_read_b64_tr_b16 v[52:53], v8 offset:12288
    ds_read_b64_tr_b16 v[54:55], v8 offset:12800
    v_mfma_f32_32x32x16_bf16 v[16:31], v[88:91], v[188:191], v[16:31]
    ds_read_b64_tr_b16 v[56:57], v8 offset:19456
    ds_read_b64_tr_b16 v[58:59], v8 offset:19968
    v_mfma_f32_32x32x16_bf16 v[96:111], v[92:95], v[188:191], v[96:111]
    ds_read_b128 v[204:207], v115 offset:0
    ds_read_b64_tr_b16 v[60:61], v8 offset:18432
    ds_read_b64_tr_b16 v[62:63], v8 offset:18944
    s_waitcnt vmcnt(6)
    s_waitcnt lgkmcnt(0)
    s_barrier
    v_mfma_f32_32x32x16_bf16 v[16:31], v[32:35], v[192:195], v[16:31]
    ds_read_b64_tr_b16 v[64:65], v8 offset:25600
    ds_read_b64_tr_b16 v[66:67], v8 offset:26112
    v_mfma_f32_32x32x16_bf16 v[96:111], v[36:39], v[192:195], v[96:111]
    ds_read_b128 v[208:211], v112 offset:8192
    ds_read_b64_tr_b16 v[68:69], v8 offset:24576
    ds_read_b64_tr_b16 v[70:71], v8 offset:25088
    v_mfma_f32_32x32x16_bf16 v[16:31], v[40:43], v[196:199], v[16:31]
    ds_read_b64_tr_b16 v[72:73], v8 offset:31744
    ds_read_b64_tr_b16 v[74:75], v8 offset:32256
    v_mfma_f32_32x32x16_bf16 v[96:111], v[44:47], v[196:199], v[96:111]
    ds_read_b128 v[212:215], v113 offset:8192
    ds_read_b64_tr_b16 v[76:77], v8 offset:30720
    ds_read_b64_tr_b16 v[78:79], v8 offset:31232
    v_mfma_f32_32x32x16_bf16 v[16:31], v[48:51], v[200:203], v[16:31]
    ds_read_b64_tr_b16 v[80:81], v8 offset:37888
    ds_read_b64_tr_b16 v[82:83], v8 offset:38400
    v_mfma_f32_32x32x16_bf16 v[96:111], v[52:55], v[200:203], v[96:111]
    ds_read_b128 v[216:219], v114 offset:8192
    ds_read_b64_tr_b16 v[84:85], v8 offset:36864
    ds_read_b64_tr_b16 v[86:87], v8 offset:37376
    v_mfma_f32_32x32x16_bf16 v[16:31], v[56:59], v[204:207], v[16:31]
    ds_read_b64_tr_b16 v[88:89], v8 offset:44032
    ds_read_b64_tr_b16 v[90:91], v8 offset:44544
    v_mfma_f32_32x32x16_bf16 v[96:111], v[60:63], v[204:207], v[96:111]
    ds_read_b128 v[220:223], v115 offset:8192
    ds_read_b64_tr_b16 v[92:93], v8 offset:43008
    ds_read_b64_tr_b16 v[94:95], v8 offset:43520
    s_waitcnt vmcnt(3)
    s_waitcnt lgkmcnt(0)
    s_barrier
    v_mfma_f32_32x32x16_bf16 v[16:31], v[64:67], v[208:211], v[16:31]
    ds_read_b64_tr_b16 v[32:33], v9 offset:1024
    ds_read_b64_tr_b16 v[34:35], v9 offset:1536
    v_mfma_f32_32x32x16_bf16 v[96:111], v[68:71], v[208:211], v[96:111]
    ds_read_b128 v[224:227], v112 offset:16384
    ds_read_b64_tr_b16 v[36:37], v9 offset:0
    ds_read_b64_tr_b16 v[38:39], v9 offset:512
    v_mfma_f32_32x32x16_bf16 v[16:31], v[72:75], v[212:215], v[16:31]
    ds_read_b64_tr_b16 v[40:41], v9 offset:7168
    ds_read_b64_tr_b16 v[42:43], v9 offset:7680
    v_mfma_f32_32x32x16_bf16 v[96:111], v[76:79], v[212:215], v[96:111]
    ds_read_b128 v[228:231], v113 offset:16384
    ds_read_b64_tr_b16 v[44:45], v9 offset:6144
    ds_read_b64_tr_b16 v[46:47], v9 offset:6656
    v_mfma_f32_32x32x16_bf16 v[16:31], v[80:83], v[216:219], v[16:31]
    ds_read_b64_tr_b16 v[48:49], v9 offset:13312
    ds_read_b64_tr_b16 v[50:51], v9 offset:13824
    v_mfma_f32_32x32x16_bf16 v[96:111], v[84:87], v[216:219], v[96:111]
    ds_read_b128 v[232:235], v114 offset:16384
    ds_read_b64_tr_b16 v[52:53], v9 offset:12288
    ds_read_b64_tr_b16 v[54:55], v9 offset:12800
    v_mfma_f32_32x32x16_bf16 v[16:31], v[88:91], v[220:223], v[16:31]
    ds_read_b64_tr_b16 v[56:57], v9 offset:19456
    ds_read_b64_tr_b16 v[58:59], v9 offset:19968
    v_mfma_f32_32x32x16_bf16 v[96:111], v[92:95], v[220:223], v[96:111]
    ds_read_b128 v[236:239], v115 offset:16384
    ds_read_b64_tr_b16 v[60:61], v9 offset:18432
    ds_read_b64_tr_b16 v[62:63], v9 offset:18944
    s_waitcnt vmcnt(0)
    s_waitcnt lgkmcnt(0)
    s_barrier
    v_mfma_f32_32x32x16_bf16 v[16:31], v[32:35], v[224:227], v[16:31]
    ds_read_b64_tr_b16 v[64:65], v9 offset:25600
    ds_read_b64_tr_b16 v[66:67], v9 offset:26112
    v_mfma_f32_32x32x16_bf16 v[96:111], v[36:39], v[224:227], v[96:111]
    ds_read_b128 v[240:243], v112 offset:24576
    ds_read_b64_tr_b16 v[68:69], v9 offset:24576
    ds_read_b64_tr_b16 v[70:71], v9 offset:25088
    v_mfma_f32_32x32x16_bf16 v[16:31], v[40:43], v[228:231], v[16:31]
    ds_read_b64_tr_b16 v[72:73], v9 offset:31744
    ds_read_b64_tr_b16 v[74:75], v9 offset:32256
    v_mfma_f32_32x32x16_bf16 v[96:111], v[44:47], v[228:231], v[96:111]
    ds_read_b128 v[244:247], v113 offset:24576
    ds_read_b64_tr_b16 v[76:77], v9 offset:30720
    ds_read_b64_tr_b16 v[78:79], v9 offset:31232
    v_mfma_f32_32x32x16_bf16 v[16:31], v[48:51], v[232:235], v[16:31]
    ds_read_b64_tr_b16 v[80:81], v9 offset:37888
    ds_read_b64_tr_b16 v[82:83], v9 offset:38400
    v_mfma_f32_32x32x16_bf16 v[96:111], v[52:55], v[232:235], v[96:111]
    ds_read_b128 v[248:251], v114 offset:24576
    ds_read_b64_tr_b16 v[84:85], v9 offset:36864
    ds_read_b64_tr_b16 v[86:87], v9 offset:37376
    v_mfma_f32_32x32x16_bf16 v[16:31], v[56:59], v[236:239], v[16:31]
    ds_read_b64_tr_b16 v[88:89], v9 offset:44032
    ds_read_b64_tr_b16 v[90:91], v9 offset:44544
    v_mfma_f32_32x32x16_bf16 v[96:111], v[60:63], v[236:239], v[96:111]
    ds_read_b128 v[252:255], v115 offset:24576
    ds_read_b64_tr_b16 v[92:93], v9 offset:43008
    ds_read_b64_tr_b16 v[94:95], v9 offset:43520
    s_waitcnt lgkmcnt(0)
    v_mfma_f32_32x32x16_bf16 v[16:31], v[64:67], v[240:243], v[16:31]
    v_mfma_f32_32x32x16_bf16 v[96:111], v[68:71], v[240:243], v[96:111]
    v_mfma_f32_32x32x16_bf16 v[16:31], v[72:75], v[244:247], v[16:31]
    v_mfma_f32_32x32x16_bf16 v[96:111], v[76:79], v[244:247], v[96:111]
    v_mfma_f32_32x32x16_bf16 v[16:31], v[80:83], v[248:251], v[16:31]
    v_mfma_f32_32x32x16_bf16 v[96:111], v[84:87], v[248:251], v[96:111]
    v_mfma_f32_32x32x16_bf16 v[16:31], v[88:91], v[252:255], v[16:31]
    v_mfma_f32_32x32x16_bf16 v[96:111], v[92:95], v[252:255], v[96:111]
    s_and_b32 s52, s56, 0x3fff
    s_lshr_b32 s52, s52, 1
    s_and_b32 s43, s56, 0xffffc000
    s_add_u32 s43, s43, s52
    s_add_u32 s43, s43, 12288
    s_mov_b32 s54, 0x3eb8aa3b
    s_add_u32 s52, s56, 0x40000
    s_lshl_b32 s53, s24, 10
    v_add_u32 v13, s53, v2
    v_mov_b32 v14, 0
    v_lshrrev_b32 v11, 2, v2
    s_nop 0
    v_mul_f32 v16, s54, v16
    v_mul_f32 v17, s54, v17
    v_mul_f32 v18, s54, v18
    v_mul_f32 v19, s54, v19
    v_mul_f32 v20, s54, v20
    v_mul_f32 v21, s54, v21
    v_mul_f32 v22, s54, v22
    v_mul_f32 v23, s54, v23
    v_mul_f32 v24, s54, v24
    v_mul_f32 v25, s54, v25
    v_mul_f32 v26, s54, v26
    v_mul_f32 v27, s54, v27
    v_mul_f32 v28, s54, v28
    v_mul_f32 v29, s54, v29
    v_mul_f32 v30, s54, v30
    v_mul_f32 v31, s54, v31
    v_cvt_pk_bf16_f32 v32, v16, v17
    v_cvt_pk_bf16_f32 v33, v18, v19
    v_cvt_pk_bf16_f32 v34, v20, v21
    v_cvt_pk_bf16_f32 v35, v22, v23
    v_cvt_pk_bf16_f32 v36, v24, v25
    v_cvt_pk_bf16_f32 v37, v26, v27
    v_cvt_pk_bf16_f32 v38, v28, v29
    v_cvt_pk_bf16_f32 v39, v30, v31
    buffer_store_dwordx4 v[32:35], v2, s[12:15], s56 offen sc1
    buffer_store_dwordx4 v[36:39], v2, s[12:15], s52 offen sc1
    s_add_u32 s52, s43, 0x40000
    v_cvt_pk_bf16_f32 v40, v96, v97
    v_cvt_pk_bf16_f32 v41, v98, v99
    v_cvt_pk_bf16_f32 v42, v100, v101
    v_cvt_pk_bf16_f32 v43, v102, v103
    v_cvt_pk_bf16_f32 v44, v104, v105
    v_cvt_pk_bf16_f32 v45, v106, v107
    v_cvt_pk_bf16_f32 v46, v108, v109
    v_cvt_pk_bf16_f32 v47, v110, v111
    buffer_store_dwordx4 v[40:43], v2, s[12:15], s43 offen sc1
    buffer_store_dwordx4 v[44:47], v2, s[12:15], s52 offen sc1
    s_bitcmp1_b32 s24, 0
    s_cbranch_scc1 L_1
    ds_write_b128 v13, v[32:35] offset:8192
    ds_write_b128 v13, v[36:39] offset:9216
    ds_write_b32 v11, v14 offset:12288
L_1:
    s_waitcnt lgkmcnt(0)
    s_barrier
    s_setprio 2
    s_and_b32 s53, s25, 1
    s_lshl_b32 s53, s53, 1
    s_lshr_b32 s52, s63, 1
    s_add_u32 s44, s53, s52
    s_lshl_b32 s52, s26, 2
    s_add_u32 s52, s52, s44
    s_lshl_b32 s52, s52, 18
    s_add_u32 s52, s52, 1052672
    s_add_u32 s16, s80, s52
    s_addc_u32 s17, s81, 0
    s_and_b32 s52, s25, 24
    s_lshl_b32 s60, s52, 13
    s_lshl_b32 s52, s32, 14
    s_add_u32 s60, s60, s52
    s_add_u32 s48, s16, s60
    s_addc_u32 s49, s17, 0
    s_mov_b32 s42, 32768
    s_lshr_b32 s52, s25, 1
    s_lshl_b32 s52, s52, 14
    s_add_u32 s52, s52, 8192
    s_add_u32 s40, s16, s52
    s_addc_u32 s41, s17, 0
    v_and_b32 v12, 27, v1
    v_cmp_ne_u32 vcc, 16, v12
    s_mov_b32 s50, 0xffff0000
    s_mov_b32 s51, 0xffff0000
    v_cndmask_b32 v12, 0, 16, vcc
    s_lshl_b32 s52, s32, 11
    v_add_u32 v6, s52, v2
    v_xor_b32 v7, 2048, v6
    s_lshl_b32 s52, s44, 10
    v_add_u32 v10, s52, v2
    v_mov_b64 v[128:129], 0
    v_mov_b64 v[130:131], 0
    v_mov_b64 v[132:133], 0
    v_mov_b64 v[134:135], 0
    v_mov_b64 v[136:137], 0
    v_mov_b64 v[138:139], 0
    v_mov_b64 v[140:141], 0
    v_mov_b64 v[142:143], 0
    v_mov_b64 v[144:145], 0
    v_mov_b64 v[146:147], 0
    v_mov_b64 v[148:149], 0
    v_mov_b64 v[150:151], 0
    v_mov_b64 v[152:153], 0
    v_mov_b64 v[154:155], 0
    v_mov_b64 v[156:157], 0
    v_mov_b64 v[158:159], 0
    v_mov_b64 v[160:161], 0
    v_mov_b64 v[162:163], 0
    v_mov_b64 v[164:165], 0
    v_mov_b64 v[166:167], 0
    v_mov_b64 v[168:169], 0
    v_mov_b64 v[170:171], 0
    v_mov_b64 v[172:173], 0
    v_mov_b64 v[174:175], 0
    v_mov_b64 v[176:177], 0
    v_mov_b64 v[178:179], 0
    v_mov_b64 v[180:181], 0
    v_mov_b64 v[182:183], 0
    v_mov_b64 v[184:185], 0
    v_mov_b64 v[186:187], 0
    v_mov_b64 v[188:189], 0
    v_mov_b64 v[190:191], 0
    v_add_u32 v13, 8192, v12
    v_cndmask_b32 v248, v3, v13, s[50:51]
    v_add_u32 v13, 7680, v12
    v_cndmask_b32 v249, v3, v13, s[50:51]
    v_add_u32 v13, 6144, v12
    v_cndmask_b32 v250, v3, v13, s[50:51]
    v_add_u32 v13, 5632, v12
    v_cndmask_b32 v251, v3, v13, s[50:51]
    v_add_u32 v13, 4096, v12
    v_cndmask_b32 v252, v3, v13, s[50:51]
    v_add_u32 v13, 3584, v12
    v_cndmask_b32 v253, v3, v13, s[50:51]
    v_add_u32 v13, 2048, v12
    v_cndmask_b32 v254, v3, v13, s[50:51]
    v_add_u32 v13, 1536, v12
    v_cndmask_b32 v255, v3, v13, s[50:51]
    ds_read_b128 v[240:243], v10 offset:8192
    v_mov_b64 v[236:237], 0
    v_mov_b64 v[238:239], 0
    v_and_b32 v11, 7, v1
    v_lshlrev_b32 v11, 7, v11
    s_and_b32 s57, s35, 0xfffffc00
    s_add_u32 s57, s57, 32768
    v_mov_b32 v5, 12288
    v_and_b32 v4, 31, v1
    v_lshlrev_b32 v4, 7, v4
    s_waitcnt vmcnt(0)
    v_mov_b32 v14, 12296
    v_mov_b32 v13, 1
    s_mov_b64 exec, 1
    ds_add_rtn_u32 v13, v14, v13
    s_waitcnt lgkmcnt(0)
    v_cmp_eq_u32 vcc, 7, v13
    s_mov_b64 exec, -1
    s_cbranch_vccz L_2
    v_mov_b32 v13, s28
    v_lshrrev_b32 v14, 2, v2
    v_add_u32 v14, 32768, v14
    s_mov_b32 exec_lo, 0xffffffff
    s_mov_b32 exec_hi, 0
    buffer_store_dword v13, v14, s[12:15], s35 offen sc1
    s_mov_b64 exec, -1
L_2:
    s_cmp_lg_u32 s63, 0
    s_cbranch_scc1 L_3
    s_mov_b32 s62, 1600000
LW_5:
    ds_read_b32 v13, v5 offset:8
    s_waitcnt lgkmcnt(0)
    v_cmp_le_u32 vcc, 8, v13
    s_cbranch_vccnz LWD_6
    s_sleep 1
    s_sub_u32 s62, s62, 1
    s_cbranch_scc0 LW_5
LWD_6:
    s_mov_b32 s62, 200000
LP_7:
    s_sleep 18
    buffer_load_dword v12, v11, s[12:15], s57 offen sc1
    s_waitcnt vmcnt(0)
    v_cmp_ne_u32 vcc, s28, v12
    s_cbranch_vccz LPD_8
    s_sub_u32 s62, s62, 1
    s_cbranch_scc0 LP_7
LPD_8:
    v_mov_b32 v13, 1
    ds_write_b32 v5, v13 offset:12
    s_branch L_4
L_3:
    s_mov_b32 s62, 1600000
LW_9:
    ds_read_b32 v13, v5 offset:12
    s_waitcnt lgkmcnt(0)
    v_cmp_le_u32 vcc, 1, v13
    s_cbranch_vccnz LWD_10
    s_sleep 1
    s_sub_u32 s62, s62, 1
    s_cbranch_scc0 LW_9
LWD_10:
L_4:
    global_load_dwordx4 v[16:19], v6, s[40:41] offset:0 sc1
    global_load_dwordx4 v[20:23], v6, s[40:41] offset:1024 sc1
    global_load_dwordx4 v[24:27], v7, s[40:41] offset:0 sc1
    global_load_dwordx4 v[28:31], v7, s[40:41] offset:1024 sc1
    global_load_dwordx4 v[192:195], v2, s[48:49] offset:-4096 sc1
    global_load_dwordx4 v[196:199], v248, s[48:49] offset:-4096 sc1
    global_load_dwordx4 v[200:203], v249, s[48:49] offset:-3584 sc1
    global_load_dwordx4 v[204:207], v2, s[48:49] offset:-2048 sc1
    global_load_dwordx4 v[208:211], v250, s[48:49] offset:-2048 sc1
    global_load_dwordx4 v[212:215], v251, s[48:49] offset:-1536 sc1
    global_load_dwordx4 v[216:219], v2, s[48:49] offset:0 sc1
    global_load_dwordx4 v[220:223], v252, s[48:49] offset:0 sc1
    global_load_dwordx4 v[224:227], v253, s[48:49] offset:512 sc1
    s_waitcnt vmcnt(9)
    v_mfma_f32_32x32x16_bf16 v[64:79], v[240:243], v[16:19], 0
    v_mfma_f32_32x32x16_bf16 v[80:95], v[240:243], v[20:23], 0
    v_mfma_f32_32x32x16_bf16 v[96:111], v[240:243], v[24:27], 0
    v_mfma_f32_32x32x16_bf16 v[112:127], v[240:243], v[28:31], 0
    v_mov_b64 v[244:245], 0
    v_mov_b64 v[246:247], 0
    s_nop 6
    v_max3_f32 v13, v64, v65, v66
    v_max_f32 v13, v13, v79
    v_max3_f32 v13, v13, v67, v68
    v_max3_f32 v13, v13, v69, v70
    v_max3_f32 v13, v13, v71, v72
    v_max3_f32 v13, v13, v73, v74
    v_max3_f32 v13, v13, v75, v76
    v_max3_f32 v13, v13, v77, v78
    v_max3_f32 v14, v80, v81, v82
    v_max_f32 v14, v14, v95
    v_max3_f32 v14, v14, v83, v84
    v_max3_f32 v14, v14, v85, v86
    v_max3_f32 v14, v14, v87, v88
    v_max3_f32 v14, v14, v89, v90
    v_max3_f32 v14, v14, v91, v92
    v_max3_f32 v14, v14, v93, v94
    v_mov_b32 v64, v13
    v_mov_b32 v80, v14
    s_nop 1
    v_permlane32_swap_b32 v64, v13
    v_permlane32_swap_b32 v80, v14
    s_nop 1
    v_max_f32 v13, v13, v64
    v_max_f32 v14, v14, v80
    v_sub_f32 v64, 0, v13
    v_sub_f32 v65, 0, v13
    v_sub_f32 v80, 0, v14
    v_sub_f32 v81, 0, v14
    v_mov_b64 v[66:67], v[64:65]
    v_mov_b64 v[68:69], v[64:65]
    v_mov_b64 v[70:71], v[64:65]
    v_mov_b64 v[72:73], v[64:65]
    v_mov_b64 v[74:75], v[64:65]
    v_mov_b64 v[76:77], v[64:65]
    v_mov_b64 v[78:79], v[64:65]
    v_mov_b64 v[82:83], v[80:81]
    v_mov_b64 v[84:85], v[80:81]
    v_mov_b64 v[86:87], v[80:81]
    v_mov_b64 v[88:89], v[80:81]
    v_mov_b64 v[90:91], v[80:81]
    v_mov_b64 v[92:93], v[80:81]
    v_mov_b64 v[94:95], v[80:81]
    s_waitcnt vmcnt(6)
    v_mfma_f32_32x32x16_bf16 v[32:47], v[192:195], v[16:19], v[64:79]
    v_max3_f32 v13, v96, v97, v98
    v_max_f32 v13, v13, v111
    v_max3_f32 v13, v13, v99, v100
    v_max3_f32 v13, v13, v101, v102
    v_max3_f32 v13, v13, v103, v104
    v_max3_f32 v13, v13, v105, v106
    v_max3_f32 v13, v13, v107, v108
    v_max3_f32 v13, v13, v109, v110
    v_max3_f32 v14, v112, v113, v114
    v_max_f32 v14, v14, v127
    v_max3_f32 v14, v14, v115, v116
    v_max3_f32 v14, v14, v117, v118
    v_max3_f32 v14, v14, v119, v120
    v_max3_f32 v14, v14, v121, v122
    v_max3_f32 v14, v14, v123, v124
    v_max3_f32 v14, v14, v125, v126
    v_mov_b32 v96, v13
    v_mov_b32 v112, v14
    s_nop 1
    v_permlane32_swap_b32 v96, v13
    v_permlane32_swap_b32 v112, v14
    s_nop 1
    v_max_f32 v13, v13, v96
    v_max_f32 v14, v14, v112
    v_sub_f32 v96, 0, v13
    v_sub_f32 v97, 0, v13
    v_sub_f32 v112, 0, v14
    v_sub_f32 v113, 0, v14
    v_mov_b64 v[98:99], v[96:97]
    v_mov_b64 v[100:101], v[96:97]
    v_mov_b64 v[102:103], v[96:97]
    v_mov_b64 v[104:105], v[96:97]
    v_mov_b64 v[106:107], v[96:97]
    v_mov_b64 v[108:109], v[96:97]
    v_mov_b64 v[110:111], v[96:97]
    v_mov_b64 v[114:115], v[112:113]
    v_mov_b64 v[116:117], v[112:113]
    v_mov_b64 v[118:119], v[112:113]
    v_mov_b64 v[120:121], v[112:113]
    v_mov_b64 v[122:123], v[112:113]
    v_mov_b64 v[124:125], v[112:113]
    v_mov_b64 v[126:127], v[112:113]
    buffer_load_dword v10, v4, s[12:15], s30 offen sc1
    s_mov_b32 s59, 0
    s_call_b64 s[94:95], L_att
    v_cmp_ne_u32 vcc, s28, v10
    s_cbranch_vccz L_kvall
    s_mov_b32 s62, 200000
LP_11:
    buffer_load_dword v10, v4, s[12:15], s30 offen sc1
    s_waitcnt vmcnt(0)
    v_cmp_ne_u32 vcc, s28, v10
    s_cbranch_vccz LPD_12
    s_sleep 4
    s_sub_u32 s62, s62, 1
    s_cbranch_scc0 LP_11
LPD_12:
L_kvall:
    s_mov_b32 s59, 6
    s_call_b64 s[94:95], L_att
    s_mul_i32 s53, s63, 4608
    v_mfma_f32_32x32x16_bf16 v[176:191], v[236:239], v[244:247], v[176:191]
    s_add_u32 s53, s53, 13312
    v_add_u32 v13, s53, v2
    v_lshl_add_u32 v14, v1, 2, s53
    s_lshl_b32 s52, s63, 2
    s_add_u32 s52, s52, 12304
    v_mov_b32 v6, s52
    v_mov_b32 v7, 1
    ds_write_b32 v6, v7 offset:16
    ds_write_b128 v13, v[160:163]
    ds_write_b128 v13, v[164:167] offset:1024
    ds_write_b32 v14, v168 offset:2048
    s_xor_b32 s52, s63, 1
    s_mul_i32 s53, s52, 4608
    ds_write_b128 v13, v[176:179] offset:2304
    ds_write_b128 v13, v[180:183] offset:3328
    ds_write_b32 v14, v184 offset:4352
    ds_write_b32 v6, v7
    s_add_u32 s53, s53, 13312
    v_add_u32 v4, s53, v2
    v_lshl_add_u32 v14, v1, 2, s53
    v_xor_b32 v6, 4, v6
    s_and_b32 s52, s25, 30
    s_add_u32 s52, s52, s32
    s_lshl_b32 s53, s26, 2
    s_add_u32 s53, s53, s44
    s_lshl_b32 s38, s52, 5
    s_add_u32 s38, s38, s53
    s_lshl_b32 s29, s38, 7
    s_lshl_b32 s38, s38, 11
    s_add_u32 s38, s38, 15728640
    s_mov_b32 s62, 1600000
    s_mov_b32 s62, 1600000
LW_13:
    ds_read_b32 v13, v6 offset:0
    s_waitcnt lgkmcnt(0)
    v_cmp_le_u32 vcc, 1, v13
    s_cbranch_vccnz LWD_14
    s_sleep 1
    s_sub_u32 s62, s62, 1
    s_cbranch_scc0 LW_13
LWD_14:
    ds_read_b128 v[32:35], v4
    ds_read_b128 v[36:39], v4 offset:1024
    ds_read_b32 v40, v14 offset:2048
    ds_read_b128 v[48:51], v4 offset:2304
    ds_read_b128 v[52:55], v4 offset:3328
    ds_read_b32 v56, v14 offset:4352
    s_waitcnt lgkmcnt(0)
    v_add_f32 v128, v128, v32
    v_add_f32 v144, v144, v48
    v_add_f32 v129, v129, v33
    v_add_f32 v145, v145, v49
    v_add_f32 v130, v130, v34
    v_add_f32 v146, v146, v50
    v_add_f32 v131, v131, v35
    v_add_f32 v147, v147, v51
    v_add_f32 v132, v132, v36
    v_add_f32 v148, v148, v52
    v_add_f32 v133, v133, v37
    v_add_f32 v149, v149, v53
    v_add_f32 v134, v134, v38
    v_add_f32 v150, v150, v54
    v_add_f32 v135, v135, v39
    v_add_f32 v151, v151, v55
    v_add_f32 v136, v136, v40
    v_add_f32 v152, v152, v56
    v_mov_b32 v13, 0x6c800000
    v_cmp_nlt_f32 vcc, v136, v13
    v_cmp_nlt_f32 s[54:55], v152, v13
    s_or_b64 vcc, vcc, s[54:55]
    s_cbranch_vccnz L_slow
L_norm:
    v_rcp_f32 v32, v136
    v_rcp_f32 v34, v152
    s_nop 0
    v_mul_f32 v128, v128, v32
    v_mul_f32 v144, v144, v34
    v_mul_f32 v129, v129, v32
    v_mul_f32 v145, v145, v34
    v_mul_f32 v130, v130, v32
    v_mul_f32 v146, v146, v34
    v_mul_f32 v131, v131, v32
    v_mul_f32 v147, v147, v34
    v_mul_f32 v132, v132, v32
    v_mul_f32 v148, v148, v34
    v_mul_f32 v133, v133, v32
    v_mul_f32 v149, v149, v34
    v_mul_f32 v134, v134, v32
    v_mul_f32 v150, v150, v34
    v_mul_f32 v135, v135, v32
    v_mul_f32 v151, v151, v34
    v_cvt_pk_bf16_f32 v64, v128, v129
    v_cvt_pk_bf16_f32 v65, v130, v131
    v_cvt_pk_bf16_f32 v66, v132, v133
    v_cvt_pk_bf16_f32 v67, v134, v135
    v_cvt_pk_bf16_f32 v68, v144, v145
    v_cvt_pk_bf16_f32 v69, v146, v147
    v_cvt_pk_bf16_f32 v70, v148, v149
    v_cvt_pk_bf16_f32 v71, v150, v151
    buffer_store_dwordx4 v[64:67], v2, s[12:15], s38 offen sc1
    buffer_store_dwordx4 v[68:71], v2, s[12:15], s38 offen offset:1024 sc1
    v_lshrrev_b32 v13, 3, v0
    v_and_b32 v14, 7, v0
    v_lshlrev_b32 v10, 10, v13
    v_lshl_add_u32 v10, v14, 4, v10
    s_lshl_b32 s52, s25, 16
    s_lshl_b32 s53, s26, 7
    s_add_u32 s60, s52, s53
    s_add_u32 s56, s60, 32768
    buffer_load_dwordx4 v[48:51], v10, s[4:7], s60 offen
    buffer_load_dwordx4 v[52:55], v10, s[4:7], s56 offen
    v_lshlrev_b32 v14, 1, v14
    v_xor_b32 v14, v14, v13
    v_and_b32 v14, 15, v14
    v_lshlrev_b32 v120, 8, v13
    v_lshl_add_u32 v120, v14, 4, v120
    v_add_u32 v120, 32768, v120
    v_xor_b32 v121, 16, v120
    v_add_u32 v122, 0x10000, v120
    v_add_u32 v123, 0x10000, v121
    v_mov_b32 v3, 12288
    s_mov_b32 s20, s76
    s_mov_b32 s21, s77
    s_mov_b32 s22, 0x200000
    s_mov_b32 s23, 0x00020000
    s_waitcnt vmcnt(2)
    v_mov_b32 v13, s28
    v_lshrrev_b32 v14, 2, v2
    v_add_u32 v14, 262144, v14
    s_mov_b32 exec_lo, 0xffffffff
    s_mov_b32 exec_hi, 0
    buffer_store_dword v13, v14, s[12:15], s29 offen sc1
    s_mov_b64 exec, -1
    s_setprio 0
    s_mov_b32 s62, 1600000
LW_15:
    ds_read_b32 v13, v3 offset:4
    s_waitcnt lgkmcnt(0)
    v_cmp_le_u32 vcc, 4, v13
    s_cbranch_vccnz LWD_16
    s_sleep 1
    s_sub_u32 s62, s62, 1
    s_cbranch_scc0 LW_15
LWD_16:
    ds_read_b128 v[128:131], v120 offset:0
    ds_read_b128 v[132:135], v121 offset:0
    ds_read_b128 v[136:139], v120 offset:32768
    ds_read_b128 v[140:143], v121 offset:32768
    ds_read_b128 v[144:147], v122 offset:0
    ds_read_b128 v[148:151], v123 offset:0
    ds_read_b128 v[152:155], v122 offset:32768
    ds_read_b128 v[156:159], v123 offset:32768
    s_waitcnt lgkmcnt(4)
    ds_read_b128 v[160:163], v120 offset:8192
    ds_read_b128 v[164:167], v121 offset:8192
    ds_read_b128 v[168:171], v120 offset:40960
    ds_read_b128 v[172:175], v121 offset:40960
    ds_read_b128 v[176:179], v122 offset:8192
    ds_read_b128 v[180:183], v123 offset:8192
    ds_read_b128 v[184:187], v122 offset:40960
    ds_read_b128 v[188:191], v123 offset:40960
    s_waitcnt vmcnt(1)
    v_lshlrev_b32 v32, 16, v48
    v_and_b32 v33, 0xffff0000, v48
    v_lshlrev_b32 v34, 16, v49
    v_and_b32 v35, 0xffff0000, v49
    v_lshlrev_b32 v36, 16, v50
    v_and_b32 v37, 0xffff0000, v50
    v_lshlrev_b32 v38, 16, v51
    v_and_b32 v39, 0xffff0000, v51
    v_lshlrev_b32 v40, 16, v52
    v_and_b32 v41, 0xffff0000, v52
    v_lshlrev_b32 v42, 16, v53
    v_and_b32 v43, 0xffff0000, v53
    v_lshlrev_b32 v44, 16, v54
    v_and_b32 v45, 0xffff0000, v54
    v_lshlrev_b32 v46, 16, v55
    v_and_b32 v47, 0xffff0000, v55
    s_waitcnt lgkmcnt(8)
    v_pk_add_f32 v[128:129], v[128:129], v[136:137]
    v_pk_add_f32 v[144:145], v[144:145], v[152:153]
    v_pk_add_f32 v[130:131], v[130:131], v[138:139]
    v_pk_add_f32 v[146:147], v[146:147], v[154:155]
    v_pk_add_f32 v[132:133], v[132:133], v[140:141]
    v_pk_add_f32 v[148:149], v[148:149], v[156:157]
    v_pk_add_f32 v[134:135], v[134:135], v[142:143]
    v_pk_add_f32 v[150:151], v[150:151], v[158:159]
    v_pk_add_f32 v[128:129], v[128:129], v[144:145]
    v_pk_add_f32 v[130:131], v[130:131], v[146:147]
    v_pk_add_f32 v[132:133], v[132:133], v[148:149]
    v_pk_add_f32 v[134:135], v[134:135], v[150:151]
    s_waitcnt lgkmcnt(0)
    v_pk_add_f32 v[160:161], v[160:161], v[168:169]
    v_pk_add_f32 v[176:177], v[176:177], v[184:185]
    v_pk_add_f32 v[162:163], v[162:163], v[170:171]
    v_pk_add_f32 v[178:179], v[178:179], v[186:187]
    v_pk_add_f32 v[164:165], v[164:165], v[172:173]
    v_pk_add_f32 v[180:181], v[180:181], v[188:189]
    v_pk_add_f32 v[166:167], v[166:167], v[174:175]
    v_pk_add_f32 v[182:183], v[182:183], v[190:191]
    v_pk_add_f32 v[160:161], v[160:161], v[176:177]
    v_pk_add_f32 v[162:163], v[162:163], v[178:179]
    v_pk_add_f32 v[164:165], v[164:165], v[180:181]
    v_pk_add_f32 v[166:167], v[166:167], v[182:183]
    v_mul_f32 v16, 0xbfb8aa3b, v128
    v_mul_f32 v17, 0xbfb8aa3b, v129
    v_mul_f32 v18, 0xbfb8aa3b, v130
    v_mul_f32 v19, 0xbfb8aa3b, v131
    v_mul_f32 v20, 0xbfb8aa3b, v132
    v_mul_f32 v21, 0xbfb8aa3b, v133
    v_mul_f32 v22, 0xbfb8aa3b, v134
    v_mul_f32 v23, 0xbfb8aa3b, v135
    v_mul_f32 v24, 0xbfb8aa3b, v160
    v_mul_f32 v25, 0xbfb8aa3b, v161
    v_mul_f32 v26, 0xbfb8aa3b, v162
    v_mul_f32 v27, 0xbfb8aa3b, v163
    v_mul_f32 v28, 0xbfb8aa3b, v164
    v_mul_f32 v29, 0xbfb8aa3b, v165
    v_mul_f32 v30, 0xbfb8aa3b, v166
    v_mul_f32 v31, 0xbfb8aa3b, v167
    v_exp_f32 v16, v16
    v_exp_f32 v17, v17
    v_exp_f32 v18, v18
    v_exp_f32 v19, v19
    v_exp_f32 v20, v20
    v_exp_f32 v21, v21
    v_exp_f32 v22, v22
    v_exp_f32 v23, v23
    v_exp_f32 v24, v24
    v_exp_f32 v25, v25
    v_exp_f32 v26, v26
    v_exp_f32 v27, v27
    v_exp_f32 v28, v28
    v_exp_f32 v29, v29
    v_exp_f32 v30, v30
    v_exp_f32 v31, v31
    s_nop 0
    v_add_f32 v16, 1.0, v16
    v_add_f32 v17, 1.0, v17
    v_add_f32 v18, 1.0, v18
    v_add_f32 v19, 1.0, v19
    v_add_f32 v20, 1.0, v20
    v_add_f32 v21, 1.0, v21
    v_add_f32 v22, 1.0, v22
    v_add_f32 v23, 1.0, v23
    v_add_f32 v24, 1.0, v24
    v_add_f32 v25, 1.0, v25
    v_add_f32 v26, 1.0, v26
    v_add_f32 v27, 1.0, v27
    v_add_f32 v28, 1.0, v28
    v_add_f32 v29, 1.0, v29
    v_add_f32 v30, 1.0, v30
    v_add_f32 v31, 1.0, v31
    v_rcp_f32 v16, v16
    v_rcp_f32 v17, v17
    v_rcp_f32 v18, v18
    v_rcp_f32 v19, v19
    v_rcp_f32 v20, v20
    v_rcp_f32 v21, v21
    v_rcp_f32 v22, v22
    v_rcp_f32 v23, v23
    v_rcp_f32 v24, v24
    v_rcp_f32 v25, v25
    v_rcp_f32 v26, v26
    v_rcp_f32 v27, v27
    v_rcp_f32 v28, v28
    v_rcp_f32 v29, v29
    v_rcp_f32 v30, v30
    v_rcp_f32 v31, v31
    s_nop 0
    v_pk_mul_f32 v[16:17], v[16:17], v[128:129]
    v_pk_mul_f32 v[18:19], v[18:19], v[130:131]
    v_pk_mul_f32 v[20:21], v[20:21], v[132:133]
    v_pk_mul_f32 v[22:23], v[22:23], v[134:135]
    v_pk_mul_f32 v[24:25], v[24:25], v[160:161]
    v_pk_mul_f32 v[26:27], v[26:27], v[162:163]
    v_pk_mul_f32 v[28:29], v[28:29], v[164:165]
    v_pk_mul_f32 v[30:31], v[30:31], v[166:167]
    s_barrier
    ds_read_b128 v[128:131], v120 offset:16384
    ds_read_b128 v[132:135], v121 offset:16384
    ds_read_b128 v[136:139], v120 offset:49152
    ds_read_b128 v[140:143], v121 offset:49152
    ds_read_b128 v[144:147], v122 offset:16384
    ds_read_b128 v[148:151], v123 offset:16384
    ds_read_b128 v[152:155], v122 offset:49152
    ds_read_b128 v[156:159], v123 offset:49152
    s_waitcnt lgkmcnt(4)
    ds_read_b128 v[160:163], v120 offset:24576
    ds_read_b128 v[164:167], v121 offset:24576
    ds_read_b128 v[168:171], v120 offset:57344
    ds_read_b128 v[172:175], v121 offset:57344
    ds_read_b128 v[176:179], v122 offset:24576
    ds_read_b128 v[180:183], v123 offset:24576
    ds_read_b128 v[184:187], v122 offset:57344
    ds_read_b128 v[188:191], v123 offset:57344
    s_waitcnt lgkmcnt(8)
    v_pk_add_f32 v[128:129], v[128:129], v[136:137]
    v_pk_add_f32 v[144:145], v[144:145], v[152:153]
    v_pk_add_f32 v[130:131], v[130:131], v[138:139]
    v_pk_add_f32 v[146:147], v[146:147], v[154:155]
    v_pk_add_f32 v[132:133], v[132:133], v[140:141]
    v_pk_add_f32 v[148:149], v[148:149], v[156:157]
    v_pk_add_f32 v[134:135], v[134:135], v[142:143]
    v_pk_add_f32 v[150:151], v[150:151], v[158:159]
    v_pk_add_f32 v[128:129], v[128:129], v[144:145]
    v_pk_add_f32 v[130:131], v[130:131], v[146:147]
    v_pk_add_f32 v[132:133], v[132:133], v[148:149]
    v_pk_add_f32 v[134:135], v[134:135], v[150:151]
    v_pk_fma_f32 v[128:129], v[128:129], v[16:17], v[32:33]
    v_pk_fma_f32 v[130:131], v[130:131], v[18:19], v[34:35]
    v_pk_fma_f32 v[132:133], v[132:133], v[20:21], v[36:37]
    v_pk_fma_f32 v[134:135], v[134:135], v[22:23], v[38:39]
    v_cvt_pk_bf16_f32 v48, v128, v129
    v_cvt_pk_bf16_f32 v49, v130, v131
    v_cvt_pk_bf16_f32 v50, v132, v133
    v_cvt_pk_bf16_f32 v51, v134, v135
    buffer_store_dwordx4 v[48:51], v10, s[20:23], s60 offen sc1
    s_waitcnt lgkmcnt(0)
    v_pk_add_f32 v[160:161], v[160:161], v[168:169]
    v_pk_add_f32 v[176:177], v[176:177], v[184:185]
    v_pk_add_f32 v[162:163], v[162:163], v[170:171]
    v_pk_add_f32 v[178:179], v[178:179], v[186:187]
    v_pk_add_f32 v[164:165], v[164:165], v[172:173]
    v_pk_add_f32 v[180:181], v[180:181], v[188:189]
    v_pk_add_f32 v[166:167], v[166:167], v[174:175]
    v_pk_add_f32 v[182:183], v[182:183], v[190:191]
    v_pk_add_f32 v[160:161], v[160:161], v[176:177]
    v_pk_add_f32 v[162:163], v[162:163], v[178:179]
    v_pk_add_f32 v[164:165], v[164:165], v[180:181]
    v_pk_add_f32 v[166:167], v[166:167], v[182:183]
    v_pk_fma_f32 v[160:161], v[160:161], v[24:25], v[40:41]
    v_pk_fma_f32 v[162:163], v[162:163], v[26:27], v[42:43]
    v_pk_fma_f32 v[164:165], v[164:165], v[28:29], v[44:45]
    v_pk_fma_f32 v[166:167], v[166:167], v[30:31], v[46:47]
    v_cvt_pk_bf16_f32 v52, v160, v161
    v_cvt_pk_bf16_f32 v53, v162, v163
    v_cvt_pk_bf16_f32 v54, v164, v165
    v_cvt_pk_bf16_f32 v55, v166, v167
    buffer_store_dwordx4 v[52:55], v10, s[20:23], s56 offen sc1
    s_or_b32 s53, s2, s63
    s_cmp_lg_u32 s53, 0
    s_cbranch_scc1 L_fin
    v_mov_b32 v13, s28
    v_lshrrev_b32 v14, 2, v2
    v_add_u32 v14, 0, v14
    s_mov_b32 exec_lo, 0xffffffff
    s_mov_b32 exec_hi, 0
    buffer_store_dword v13, v14, s[12:15], s53 offen sc1
    s_mov_b64 exec, -1
    s_branch L_fin
L_fwave:
    s_waitcnt vmcnt(3)
    s_waitcnt lgkmcnt(0)
    s_barrier
    ds_read_b128 v[128:131], v112 offset:0
    ds_read_b64_tr_b16 v[32:33], v8 offset:2048
    ds_read_b64_tr_b16 v[34:35], v8 offset:2560
    s_mul_i32 s54, s91, 393216
    s_add_u32 m0, s31, 49152
    s_add_u32 s54, s54, s36
    buffer_load_dwordx4 v4, s[8:11], s54 offen lds
    buffer_load_dwordx4 v4, s[8:11], s54 offen offset:1024 lds
    ds_read_b128 v[132:135], v113 offset:0
    ds_read_b64_tr_b16 v[40:41], v8 offset:8192
    ds_read_b64_tr_b16 v[42:43], v8 offset:8704
    buffer_load_dwordx4 v4, s[8:11], s54 offen offset:2048 lds
    s_mul_i32 s54, s91, 393216
    s_add_u32 m0, s31, 73728
    s_add_u32 s54, s54, s36
    s_add_u32 s54, s54, 196608
    buffer_load_dwordx4 v4, s[8:11], s54 offen lds
    ds_read_b128 v[136:139], v114 offset:0
    ds_read_b64_tr_b16 v[48:49], v8 offset:14336
    ds_read_b64_tr_b16 v[50:51], v8 offset:14848
    buffer_load_dwordx4 v4, s[8:11], s54 offen offset:1024 lds
    ds_read_b128 v[140:143], v115 offset:0
    ds_read_b64_tr_b16 v[56:57], v8 offset:20480
    ds_read_b64_tr_b16 v[58:59], v8 offset:20992
    buffer_load_dwordx4 v4, s[8:11], s54 offen offset:2048 lds
    s_waitcnt vmcnt(6)
    s_waitcnt lgkmcnt(0)
    s_barrier
    v_mfma_f32_32x32x16_bf16 v[16:31], v[128:131], v[32:35], 0
    ds_read_b128 v[144:147], v112 offset:8192
    ds_read_b64_tr_b16 v[64:65], v8 offset:26624
    ds_read_b64_tr_b16 v[66:67], v8 offset:27136
    s_mul_i32 s54, s92, 393216
    s_add_u32 m0, s31, 0
    s_add_u32 s54, s54, s36
    buffer_load_dwordx4 v4, s[8:11], s54 offen lds
    v_mfma_f32_32x32x16_bf16 v[16:31], v[132:135], v[40:43], v[16:31]
    ds_read_b128 v[148:151], v113 offset:8192
    ds_read_b64_tr_b16 v[72:73], v8 offset:32768
    ds_read_b64_tr_b16 v[74:75], v8 offset:33280
    buffer_load_dwordx4 v4, s[8:11], s54 offen offset:1024 lds
    v_mfma_f32_32x32x16_bf16 v[16:31], v[136:139], v[48:51], v[16:31]
    ds_read_b128 v[152:155], v114 offset:8192
    ds_read_b64_tr_b16 v[80:81], v8 offset:38912
    ds_read_b64_tr_b16 v[82:83], v8 offset:39424
    buffer_load_dwordx4 v4, s[8:11], s54 offen offset:2048 lds
    v_mfma_f32_32x32x16_bf16 v[16:31], v[140:143], v[56:59], v[16:31]
    ds_read_b128 v[156:159], v115 offset:8192
    ds_read_b64_tr_b16 v[88:89], v8 offset:45056
    ds_read_b64_tr_b16 v[90:91], v8 offset:45568
    s_waitcnt vmcnt(6)
    s_waitcnt lgkmcnt(0)
    s_barrier
    v_mfma_f32_32x32x16_bf16 v[16:31], v[144:147], v[64:67], v[16:31]
    ds_read_b128 v[160:163], v112 offset:16384
    ds_read_b64_tr_b16 v[32:33], v9 offset:2048
    ds_read_b64_tr_b16 v[34:35], v9 offset:2560
    s_mul_i32 s54, s92, 393216
    s_add_u32 m0, s31, 24576
    s_add_u32 s54, s54, s36
    s_add_u32 s54, s54, 196608
    buffer_load_dwordx4 v4, s[8:11], s54 offen lds
    v_mfma_f32_32x32x16_bf16 v[16:31], v[148:151], v[72:75], v[16:31]
    ds_read_b128 v[164:167], v113 offset:16384
    ds_read_b64_tr_b16 v[40:41], v9 offset:8192
    ds_read_b64_tr_b16 v[42:43], v9 offset:8704
    buffer_load_dwordx4 v4, s[8:11], s54 offen offset:1024 lds
    v_mfma_f32_32x32x16_bf16 v[16:31], v[152:155], v[80:83], v[16:31]
    ds_read_b128 v[168:171], v114 offset:16384
    ds_read_b64_tr_b16 v[48:49], v9 offset:14336
    ds_read_b64_tr_b16 v[50:51], v9 offset:14848
    buffer_load_dwordx4 v4, s[8:11], s54 offen offset:2048 lds
    v_mfma_f32_32x32x16_bf16 v[16:31], v[156:159], v[88:91], v[16:31]
    ds_read_b128 v[172:175], v115 offset:16384
    ds_read_b64_tr_b16 v[56:57], v9 offset:20480
    ds_read_b64_tr_b16 v[58:59], v9 offset:20992
    s_waitcnt vmcnt(6)
    s_waitcnt lgkmcnt(0)
    s_barrier
    v_mfma_f32_32x32x16_bf16 v[16:31], v[160:163], v[32:35], v[16:31]
    ds_read_b128 v[176:179], v112 offset:24576
    ds_read_b64_tr_b16 v[64:65], v9 offset:26624
    ds_read_b64_tr_b16 v[66:67], v9 offset:27136
    s_mul_i32 s54, s93, 393216
    s_add_u32 m0, s31, 49152
    s_add_u32 s54, s54, s36
    buffer_load_dwordx4 v4, s[8:11], s54 offen lds
    v_mfma_f32_32x32x16_bf16 v[16:31], v[164:167], v[40:43], v[16:31]
    ds_read_b128 v[180:183], v113 offset:24576
    ds_read_b64_tr_b16 v[72:73], v9 offset:32768
    ds_read_b64_tr_b16 v[74:75], v9 offset:33280
    buffer_load_dwordx4 v4, s[8:11], s54 offen offset:1024 lds
    v_mfma_f32_32x32x16_bf16 v[16:31], v[168:171], v[48:51], v[16:31]
    ds_read_b128 v[184:187], v114 offset:24576
    ds_read_b64_tr_b16 v[80:81], v9 offset:38912
    ds_read_b64_tr_b16 v[82:83], v9 offset:39424
    buffer_load_dwordx4 v4, s[8:11], s54 offen offset:2048 lds
    v_mfma_f32_32x32x16_bf16 v[16:31], v[172:175], v[56:59], v[16:31]
    ds_read_b128 v[188:191], v115 offset:24576
    ds_read_b64_tr_b16 v[88:89], v9 offset:45056
    ds_read_b64_tr_b16 v[90:91], v9 offset:45568
    s_lshl_b32 s3, s2, 2
    s_add_u32 s3, s3, s63
    s_mul_i32 s52, s3, 1408
    v_lshl_add_u32 v125, v1, 7, s52
    v_min_u32 v125, 1409020, v125
    s_mov_b64 exec, 0x7ff
    global_load_dword v126, v125, s[72:73]
    s_mov_b64 exec, -1
    v_subrev_u32 v112, 131072, v112
    v_subrev_u32 v113, 131072, v113
    v_subrev_u32 v114, 131072, v114
    v_subrev_u32 v115, 131072, v115
    v_mov_b64 v[104:105], 0
    v_mov_b64 v[106:107], 0
    s_mov_b64 exec, 1
    v_mov_b32 v104, s46
    v_mov_b32 v105, s46
    v_mov_b32 v106, s46
    v_mov_b32 v107, s46
    s_and_b32 s52, s56, 0xffffc000
    s_lshl_b32 s53, s32, 18
    s_add_u32 s52, s52, s53
    s_add_u32 s52, s52, 8192
    s_mov_b64 exec, 0xff
    buffer_store_dwordx4 v[104:107], v2, s[12:15], s52 offen sc1
    s_mov_b64 exec, -1
    v_add_u32 v13, 0, v1
    v_mul_u32_u24 v14, 2731, v13
    v_lshrrev_b32 v14, 16, v14
    v_mul_u32_u24 v116, 24, v14
    v_sub_u32 v13, v13, v116
    v_mul_u32_u24 v116, 2752, v14
    v_lshlrev_b32 v14, 1, v14
    v_and_b32 v14, 4, v14
    v_xor_b32 v13, v13, v14
    v_lshl_add_u32 v116, v13, 4, v116
    v_add_u32 v13, 64, v1
    v_mul_u32_u24 v14, 2731, v13
    v_lshrrev_b32 v14, 16, v14
    v_mul_u32_u24 v117, 24, v14
    v_sub_u32 v13, v13, v117
    v_mul_u32_u24 v117, 2752, v14
    v_lshlrev_b32 v14, 1, v14
    v_and_b32 v14, 4, v14
    v_xor_b32 v13, v13, v14
    v_lshl_add_u32 v117, v13, 4, v117
    v_subrev_u32 v117, 1024, v117
    v_add_u32 v13, 128, v1
    v_mul_u32_u24 v14, 2731, v13
    v_lshrrev_b32 v14, 16, v14
    v_mul_u32_u24 v118, 24, v14
    v_sub_u32 v13, v13, v118
    v_mul_u32_u24 v118, 2752, v14
    v_lshlrev_b32 v14, 1, v14
    v_and_b32 v14, 4, v14
    v_xor_b32 v13, v13, v14
    v_lshl_add_u32 v118, v13, 4, v118
    v_subrev_u32 v118, 2048, v118
    s_mul_i32 s52, s25, 176128
    s_add_u32 s52, s52, 9437184
    s_add_u32 s16, s80, s52
    s_addc_u32 s17, s81, 0
    s_mov_b32 s18, 176128
    s_mov_b32 s19, 0x00020000
    s_waitcnt vmcnt(8)
    s_waitcnt lgkmcnt(0)
    s_barrier
    v_mfma_f32_32x32x16_bf16 v[16:31], v[176:179], v[64:67], v[16:31]
    ds_read_b128 v[192:195], v112 offset:0
    ds_read_b64_tr_b16 v[32:33], v8 offset:2048
    ds_read_b64_tr_b16 v[34:35], v8 offset:2560
    s_mul_i32 s54, s93, 393216
    s_add_u32 m0, s31, 73728
    s_add_u32 s54, s54, s36
    s_add_u32 s54, s54, 196608
    buffer_load_dwordx4 v4, s[8:11], s54 offen lds
    v_mfma_f32_32x32x16_bf16 v[16:31], v[180:183], v[72:75], v[16:31]
    ds_read_b128 v[196:199], v113 offset:0
    ds_read_b64_tr_b16 v[40:41], v8 offset:8192
    ds_read_b64_tr_b16 v[42:43], v8 offset:8704
    buffer_load_dwordx4 v4, s[8:11], s54 offen offset:1024 lds
    v_mfma_f32_32x32x16_bf16 v[16:31], v[184:187], v[80:83], v[16:31]
    ds_read_b128 v[200:203], v114 offset:0
    ds_read_b64_tr_b16 v[48:49], v8 offset:14336
    ds_read_b64_tr_b16 v[50:51], v8 offset:14848
    buffer_load_dwordx4 v4, s[8:11], s54 offen offset:2048 lds
    v_mfma_f32_32x32x16_bf16 v[16:31], v[188:191], v[88:91], v[16:31]
    ds_read_b128 v[204:207], v115 offset:0
    ds_read_b64_tr_b16 v[56:57], v8 offset:20480
    ds_read_b64_tr_b16 v[58:59], v8 offset:20992
    s_waitcnt vmcnt(8)
    s_waitcnt lgkmcnt(0)
    s_barrier
    v_mfma_f32_32x32x16_bf16 v[16:31], v[192:195], v[32:35], v[16:31]
    ds_read_b128 v[208:211], v112 offset:8192
    ds_read_b64_tr_b16 v[64:65], v8 offset:26624
    ds_read_b64_tr_b16 v[66:67], v8 offset:27136
    s_mul_i32 s54, s90, 352256
    s_add_u32 m0, s39, 98304
    s_add_u32 s54, s54, s37
    buffer_load_dwordx4 v116, s[96:99], s54 offen offset:0 lds
    buffer_load_dwordx4 v117, s[96:99], s54 offen offset:1024 lds
    v_mfma_f32_32x32x16_bf16 v[16:31], v[196:199], v[40:43], v[16:31]
    ds_read_b128 v[212:215], v113 offset:8192
    ds_read_b64_tr_b16 v[72:73], v8 offset:32768
    ds_read_b64_tr_b16 v[74:75], v8 offset:33280
    buffer_load_dwordx4 v118, s[96:99], s54 offen offset:2048 lds
    s_add_u32 m0, s39, 101376
    s_add_u32 s54, s54, 22016
    buffer_load_dwordx4 v116, s[96:99], s54 offen offset:0 lds
    v_mfma_f32_32x32x16_bf16 v[16:31], v[200:203], v[48:51], v[16:31]
    ds_read_b128 v[216:219], v114 offset:8192
    ds_read_b64_tr_b16 v[80:81], v8 offset:38912
    ds_read_b64_tr_b16 v[82:83], v8 offset:39424
    buffer_load_dwordx4 v117, s[96:99], s54 offen offset:1024 lds
    v_mfma_f32_32x32x16_bf16 v[16:31], v[204:207], v[56:59], v[16:31]
    ds_read_b128 v[220:223], v115 offset:8192
    ds_read_b64_tr_b16 v[88:89], v8 offset:45056
    ds_read_b64_tr_b16 v[90:91], v8 offset:45568
    buffer_load_dwordx4 v118, s[96:99], s54 offen offset:2048 lds
    s_waitcnt vmcnt(11)
    s_waitcnt lgkmcnt(0)
    s_barrier
    v_mfma_f32_32x32x16_bf16 v[16:31], v[208:211], v[64:67], v[16:31]
    ds_read_b128 v[224:227], v112 offset:16384
    ds_read_b64_tr_b16 v[32:33], v9 offset:2048
    ds_read_b64_tr_b16 v[34:35], v9 offset:2560
    s_mul_i32 s54, s90, 352256
    s_add_u32 m0, s39, 0
    s_add_u32 s54, s54, s37
    s_add_u32 s54, s54, 176128
    buffer_load_dwordx4 v116, s[96:99], s54 offen offset:0 lds
    buffer_load_dwordx4 v117, s[96:99], s54 offen offset:1024 lds
    v_mfma_f32_32x32x16_bf16 v[16:31], v[212:215], v[72:75], v[16:31]
    ds_read_b128 v[228:231], v113 offset:16384
    ds_read_b64_tr_b16 v[40:41], v9 offset:8192
    ds_read_b64_tr_b16 v[42:43], v9 offset:8704
    buffer_load_dwordx4 v118, s[96:99], s54 offen offset:2048 lds
    s_add_u32 m0, s39, 3072
    s_add_u32 s54, s54, 22016
    buffer_load_dwordx4 v116, s[96:99], s54 offen offset:0 lds
    v_mfma_f32_32x32x16_bf16 v[16:31], v[216:219], v[80:83], v[16:31]
    ds_read_b128 v[232:235], v114 offset:16384
    ds_read_b64_tr_b16 v[48:49], v9 offset:14336
    ds_read_b64_tr_b16 v[50:51], v9 offset:14848
    buffer_load_dwordx4 v117, s[96:99], s54 offen offset:1024 lds
    v_mfma_f32_32x32x16_bf16 v[16:31], v[220:223], v[88:91], v[16:31]
    ds_read_b128 v[236:239], v115 offset:16384
    ds_read_b64_tr_b16 v[56:57], v9 offset:20480
    ds_read_b64_tr_b16 v[58:59], v9 offset:20992
    buffer_load_dwordx4 v118, s[96:99], s54 offen offset:2048 lds
    s_waitcnt vmcnt(12)
    s_waitcnt lgkmcnt(0)
    s_barrier
    v_mfma_f32_32x32x16_bf16 v[16:31], v[224:227], v[32:35], v[16:31]
    ds_read_b128 v[240:243], v112 offset:24576
    ds_read_b64_tr_b16 v[64:65], v9 offset:26624
    ds_read_b64_tr_b16 v[66:67], v9 offset:27136
    s_mul_i32 s54, s91, 352256
    s_add_u32 m0, s39, 32768
    s_add_u32 s54, s54, s37
    buffer_load_dwordx4 v116, s[96:99], s54 offen offset:0 lds
    buffer_load_dwordx4 v117, s[96:99], s54 offen offset:1024 lds
    v_mfma_f32_32x32x16_bf16 v[16:31], v[228:231], v[40:43], v[16:31]
    ds_read_b128 v[244:247], v113 offset:24576
    ds_read_b64_tr_b16 v[72:73], v9 offset:32768
    ds_read_b64_tr_b16 v[74:75], v9 offset:33280
    buffer_load_dwordx4 v118, s[96:99], s54 offen offset:2048 lds
    s_add_u32 m0, s39, 35840
    s_add_u32 s54, s54, 22016
    buffer_load_dwordx4 v116, s[96:99], s54 offen offset:0 lds
    v_mfma_f32_32x32x16_bf16 v[16:31], v[232:235], v[48:51], v[16:31]
    ds_read_b128 v[248:251], v114 offset:24576
    ds_read_b64_tr_b16 v[80:81], v9 offset:38912
    ds_read_b64_tr_b16 v[82:83], v9 offset:39424
    buffer_load_dwordx4 v117, s[96:99], s54 offen offset:1024 lds
    v_mfma_f32_32x32x16_bf16 v[16:31], v[236:239], v[56:59], v[16:31]
    ds_read_b128 v[252:255], v115 offset:24576
    ds_read_b64_tr_b16 v[88:89], v9 offset:45056
    ds_read_b64_tr_b16 v[90:91], v9 offset:45568
    buffer_load_dwordx4 v118, s[96:99], s54 offen offset:2048 lds
    s_waitcnt lgkmcnt(0)
    v_mfma_f32_32x32x16_bf16 v[16:31], v[240:243], v[64:67], v[16:31]
    v_mfma_f32_32x32x16_bf16 v[16:31], v[244:247], v[72:75], v[16:31]
    v_mfma_f32_32x32x16_bf16 v[16:31], v[248:251], v[80:83], v[16:31]
    v_mfma_f32_32x32x16_bf16 v[16:31], v[252:255], v[88:91], v[16:31]
    s_nop 11
    v_cvt_pk_bf16_f32 v96, v16, v17
    v_cvt_pk_bf16_f32 v97, v18, v19
    v_cvt_pk_bf16_f32 v98, v20, v21
    v_cvt_pk_bf16_f32 v99, v22, v23
    v_cvt_pk_bf16_f32 v100, v24, v25
    v_cvt_pk_bf16_f32 v101, v26, v27
    v_cvt_pk_bf16_f32 v102, v28, v29
    v_cvt_pk_bf16_f32 v103, v30, v31
    buffer_store_dwordx4 v[96:99], v10, s[12:15], s56 offen sc1
    buffer_store_dwordx4 v[100:103], v10, s[12:15], s56 offen offset:512 sc1
    s_waitcnt lgkmcnt(0)
    s_barrier
    v_mov_b32 v3, 12288
    v_sub_u32 v11, 1, v1
    v_max_i32 v11, 0, v11
    s_lshl_b32 s61, s63, 15
    s_add_u32 s61, s61, 32768
    v_mov_b32 v4, v127
    v_add_u32 v5, 7168, v127
    v_add_u32 v6, s61, v124
    v_xor_b32 v7, 64, v6
    v_and_b32 v8, 31, v1
    v_lshlrev_b32 v8, 7, v8
    s_setprio 0
    s_mov_b32 s8, s74
    s_mov_b32 s9, s75
    s_mov_b32 s10, 0x158000
    s_mov_b32 s20, s68
    s_mov_b32 s21, s69
    s_mov_b32 s22, 0x80000
    s_mov_b32 s23, 0x00020000
    s_lshl_b32 s52, s26, 7
    s_mul_i32 s33, s63, 360448
    s_add_u32 s33, s33, s52
    s_lshl_b32 s36, s63, 14
    s_add_u32 s36, s36, s52
    s_lshl_b32 s31, s63, 11
    s_mul_i32 s34, s63, 45056
    s_waitcnt vmcnt(14)
    s_setprio 3
    s_mov_b64 exec, 1
    ds_add_u32 v3, v11
    s_mov_b64 exec, -1
    s_mov_b32 s62, 1600000
LW_17:
    ds_read_b32 v13, v3 offset:0
    s_waitcnt lgkmcnt(0)
    v_cmp_le_u32 vcc, 4, v13
    s_cbranch_vccnz LWD_18
    s_sleep 1
    s_sub_u32 s62, s62, 1
    s_cbranch_scc0 LW_17
LWD_18:
    s_setprio 0
    ds_read_b64_tr_b16 v[32:33], v121 offset:32768
    ds_read_b64_tr_b16 v[34:35], v121 offset:34304
    ds_read_b64_tr_b16 v[36:37], v121 offset:32896
    ds_read_b64_tr_b16 v[38:39], v121 offset:34432
    ds_read_b64_tr_b16 v[40:41], v121 offset:33024
    ds_read_b64_tr_b16 v[42:43], v121 offset:34560
    ds_read_b64_tr_b16 v[44:45], v121 offset:38912
    ds_read_b64_tr_b16 v[46:47], v121 offset:40448
    ds_read_b64_tr_b16 v[48:49], v121 offset:39040
    ds_read_b64_tr_b16 v[50:51], v121 offset:40576
    ds_read_b64_tr_b16 v[52:53], v121 offset:39168
    ds_read_b64_tr_b16 v[54:55], v121 offset:40704
    s_waitcnt lgkmcnt(6)
    ds_read_b64_tr_b16 v[56:57], v121 offset:45056
    ds_read_b64_tr_b16 v[58:59], v121 offset:46592
    ds_read_b64_tr_b16 v[60:61], v121 offset:45184
    ds_read_b64_tr_b16 v[62:63], v121 offset:46720
    ds_read_b64_tr_b16 v[64:65], v121 offset:45312
    ds_read_b64_tr_b16 v[66:67], v121 offset:46848
    s_waitcnt lgkmcnt(12)
    v_mfma_f32_32x32x16_bf16 v[16:31], v[32:35], v[128:131], 0
    v_mfma_f32_32x32x16_bf16 v[96:111], v[36:39], v[128:131], 0
    v_mfma_f32_32x32x16_bf16 v[80:95], v[40:43], v[128:131], 0
    s_waitcnt lgkmcnt(6)
    ds_read_b64_tr_b16 v[68:69], v121 offset:51200
    ds_read_b64_tr_b16 v[70:71], v121 offset:52736
    ds_read_b64_tr_b16 v[72:73], v121 offset:51328
    ds_read_b64_tr_b16 v[74:75], v121 offset:52864
    ds_read_b64_tr_b16 v[76:77], v121 offset:51456
    ds_read_b64_tr_b16 v[78:79], v121 offset:52992
    s_waitcnt lgkmcnt(12)
    v_mfma_f32_32x32x16_bf16 v[16:31], v[44:47], v[132:135], v[16:31]
    v_mfma_f32_32x32x16_bf16 v[96:111], v[48:51], v[132:135], v[96:111]
    v_mfma_f32_32x32x16_bf16 v[80:95], v[52:55], v[132:135], v[80:95]
    s_waitcnt lgkmcnt(6)
    v_mfma_f32_32x32x16_bf16 v[16:31], v[56:59], v[136:139], v[16:31]
    v_mfma_f32_32x32x16_bf16 v[96:111], v[60:63], v[136:139], v[96:111]
    v_mfma_f32_32x32x16_bf16 v[80:95], v[64:67], v[136:139], v[80:95]
    s_waitcnt lgkmcnt(0)
    v_mfma_f32_32x32x16_bf16 v[16:31], v[68:71], v[140:143], v[16:31]
    v_mfma_f32_32x32x16_bf16 v[96:111], v[72:75], v[140:143], v[96:111]
    v_mfma_f32_32x32x16_bf16 v[80:95], v[76:79], v[140:143], v[80:95]
    s_waitcnt vmcnt(0)
    v_mov_b32 v14, 12296
    v_mov_b32 v13, 1
    s_mov_b64 exec, 1
    ds_add_rtn_u32 v13, v14, v13
    s_waitcnt lgkmcnt(0)
    v_cmp_eq_u32 vcc, 7, v13
    s_mov_b64 exec, -1
    s_cbranch_vccz L_19
    v_mov_b32 v13, s28
    v_lshrrev_b32 v14, 2, v2
    v_add_u32 v14, 32768, v14
    s_mov_b32 exec_lo, 0xffffffff
    s_mov_b32 exec_hi, 0
    buffer_store_dword v13, v14, s[12:15], s35 offen sc1
    s_mov_b64 exec, -1
L_19:
    s_mov_b32 s62, 1600000
LW_20:
    ds_read_b32 v13, v3 offset:8
    s_waitcnt lgkmcnt(0)
    v_cmp_le_u32 vcc, 8, v13
    s_cbranch_vccnz LWD_21
    s_sleep 1
    s_sub_u32 s62, s62, 1
    s_cbranch_scc0 LW_20
LWD_21:
    s_waitcnt vmcnt(8)
    s_setprio 3
    s_mov_b64 exec, 1
    ds_add_u32 v3, v11
    s_mov_b64 exec, -1
    s_mov_b32 s62, 1600000
LW_22:
    ds_read_b32 v13, v3 offset:0
    s_waitcnt lgkmcnt(0)
    v_cmp_le_u32 vcc, 8, v13
    s_cbranch_vccnz LWD_23
    s_sleep 1
    s_sub_u32 s62, s62, 1
    s_cbranch_scc0 LW_22
LWD_23:
    s_setprio 0
    ds_read_b64_tr_b16 v[32:33], v120 offset:0
    ds_read_b64_tr_b16 v[34:35], v120 offset:1536
    ds_read_b64_tr_b16 v[36:37], v120 offset:128
    ds_read_b64_tr_b16 v[38:39], v120 offset:1664
    ds_read_b64_tr_b16 v[40:41], v120 offset:256
    ds_read_b64_tr_b16 v[42:43], v120 offset:1792
    ds_read_b64_tr_b16 v[44:45], v120 offset:6144
    ds_read_b64_tr_b16 v[46:47], v120 offset:7680
    ds_read_b64_tr_b16 v[48:49], v120 offset:6272
    ds_read_b64_tr_b16 v[50:51], v120 offset:7808
    ds_read_b64_tr_b16 v[52:53], v120 offset:6400
    ds_read_b64_tr_b16 v[54:55], v120 offset:7936
    s_waitcnt lgkmcnt(6)
    ds_read_b64_tr_b16 v[56:57], v120 offset:12288
    ds_read_b64_tr_b16 v[58:59], v120 offset:13824
    ds_read_b64_tr_b16 v[60:61], v120 offset:12416
    ds_read_b64_tr_b16 v[62:63], v120 offset:13952
    ds_read_b64_tr_b16 v[64:65], v120 offset:12544
    ds_read_b64_tr_b16 v[66:67], v120 offset:14080
    s_waitcnt lgkmcnt(12)
    v_mfma_f32_32x32x16_bf16 v[16:31], v[32:35], v[144:147], v[16:31]
    s_mul_i32 s54, s91, 352256
    s_add_u32 m0, s39, 65536
    s_add_u32 s54, s54, s37
    s_add_u32 s54, s54, 176128
    buffer_load_dwordx4 v116, s[96:99], s54 offen offset:0 lds
    v_mfma_f32_32x32x16_bf16 v[96:111], v[36:39], v[144:147], v[96:111]
    buffer_load_dwordx4 v117, s[96:99], s54 offen offset:1024 lds
    v_mfma_f32_32x32x16_bf16 v[80:95], v[40:43], v[144:147], v[80:95]
    buffer_load_dwordx4 v118, s[96:99], s54 offen offset:2048 lds
    s_waitcnt lgkmcnt(6)
    ds_read_b64_tr_b16 v[68:69], v120 offset:18432
    ds_read_b64_tr_b16 v[70:71], v120 offset:19968
    ds_read_b64_tr_b16 v[72:73], v120 offset:18560
    ds_read_b64_tr_b16 v[74:75], v120 offset:20096
    ds_read_b64_tr_b16 v[76:77], v120 offset:18688
    ds_read_b64_tr_b16 v[78:79], v120 offset:20224
    s_waitcnt lgkmcnt(12)
    v_mfma_f32_32x32x16_bf16 v[16:31], v[44:47], v[148:151], v[16:31]
    s_add_u32 m0, s39, 68608
    s_add_u32 s54, s54, 22016
    buffer_load_dwordx4 v116, s[96:99], s54 offen offset:0 lds
    v_mfma_f32_32x32x16_bf16 v[96:111], v[48:51], v[148:151], v[96:111]
    buffer_load_dwordx4 v117, s[96:99], s54 offen offset:1024 lds
    v_mfma_f32_32x32x16_bf16 v[80:95], v[52:55], v[148:151], v[80:95]
    buffer_load_dwordx4 v118, s[96:99], s54 offen offset:2048 lds
    s_waitcnt lgkmcnt(6)
    v_mfma_f32_32x32x16_bf16 v[16:31], v[56:59], v[152:155], v[16:31]
    s_mul_i32 s54, s92, 352256
    s_add_u32 m0, s39, 98304
    s_add_u32 s54, s54, s37
    buffer_load_dwordx4 v116, s[96:99], s54 offen offset:0 lds
    v_mfma_f32_32x32x16_bf16 v[96:111], v[60:63], v[152:155], v[96:111]
    buffer_load_dwordx4 v117, s[96:99], s54 offen offset:1024 lds
    v_mfma_f32_32x32x16_bf16 v[80:95], v[64:67], v[152:155], v[80:95]
    buffer_load_dwordx4 v118, s[96:99], s54 offen offset:2048 lds
    s_waitcnt lgkmcnt(0)
    v_mfma_f32_32x32x16_bf16 v[16:31], v[68:71], v[156:159], v[16:31]
    s_add_u32 m0, s39, 101376
    s_add_u32 s54, s54, 22016
    buffer_load_dwordx4 v116, s[96:99], s54 offen offset:0 lds
    v_mfma_f32_32x32x16_bf16 v[96:111], v[72:75], v[156:159], v[96:111]
    buffer_load_dwordx4 v117, s[96:99], s54 offen offset:1024 lds
    v_mfma_f32_32x32x16_bf16 v[80:95], v[76:79], v[156:159], v[80:95]
    buffer_load_dwordx4 v118, s[96:99], s54 offen offset:2048 lds
    s_waitcnt vmcnt(14)
    s_setprio 3
    s_mov_b64 exec, 1
    ds_add_u32 v3, v11
    s_mov_b64 exec, -1
    s_mov_b32 s62, 1600000
LW_24:
    ds_read_b32 v13, v3 offset:0
    s_waitcnt lgkmcnt(0)
    v_cmp_le_u32 vcc, 12, v13
    s_cbranch_vccnz LWD_25
    s_sleep 1
    s_sub_u32 s62, s62, 1
    s_cbranch_scc0 LW_24
LWD_25:
    s_setprio 0
    ds_read_b64_tr_b16 v[32:33], v120 offset:32768
    ds_read_b64_tr_b16 v[34:35], v120 offset:34304
    ds_read_b64_tr_b16 v[36:37], v120 offset:32896
    ds_read_b64_tr_b16 v[38:39], v120 offset:34432
    ds_read_b64_tr_b16 v[40:41], v120 offset:33024
    ds_read_b64_tr_b16 v[42:43], v120 offset:34560
    ds_read_b64_tr_b16 v[44:45], v120 offset:38912
    ds_read_b64_tr_b16 v[46:47], v120 offset:40448
    ds_read_b64_tr_b16 v[48:49], v120 offset:39040
    ds_read_b64_tr_b16 v[50:51], v120 offset:40576
    ds_read_b64_tr_b16 v[52:53], v120 offset:39168
    ds_read_b64_tr_b16 v[54:55], v120 offset:40704
    s_waitcnt lgkmcnt(6)
    ds_read_b64_tr_b16 v[56:57], v120 offset:45056
    ds_read_b64_tr_b16 v[58:59], v120 offset:46592
    ds_read_b64_tr_b16 v[60:61], v120 offset:45184
    ds_read_b64_tr_b16 v[62:63], v120 offset:46720
    ds_read_b64_tr_b16 v[64:65], v120 offset:45312
    ds_read_b64_tr_b16 v[66:67], v120 offset:46848
    s_waitcnt lgkmcnt(12)
    v_mfma_f32_32x32x16_bf16 v[16:31], v[32:35], v[160:163], v[16:31]
    s_mul_i32 s54, s92, 352256
    s_add_u32 m0, s39, 0
    s_add_u32 s54, s54, s37
    s_add_u32 s54, s54, 176128
    buffer_load_dwordx4 v116, s[96:99], s54 offen offset:0 lds
    v_mfma_f32_32x32x16_bf16 v[96:111], v[36:39], v[160:163], v[96:111]
    v_mfma_f32_32x32x16_bf16 v[80:95], v[40:43], v[160:163], v[80:95]
    buffer_load_dwordx4 v117, s[96:99], s54 offen offset:1024 lds
    s_waitcnt lgkmcnt(6)
    ds_read_b64_tr_b16 v[68:69], v120 offset:51200
    ds_read_b64_tr_b16 v[70:71], v120 offset:52736
    ds_read_b64_tr_b16 v[72:73], v120 offset:51328
    ds_read_b64_tr_b16 v[74:75], v120 offset:52864
    ds_read_b64_tr_b16 v[76:77], v120 offset:51456
    ds_read_b64_tr_b16 v[78:79], v120 offset:52992
    s_waitcnt lgkmcnt(12)
    v_mfma_f32_32x32x16_bf16 v[16:31], v[44:47], v[164:167], v[16:31]
    v_mfma_f32_32x32x16_bf16 v[96:111], v[48:51], v[164:167], v[96:111]
    buffer_load_dwordx4 v118, s[96:99], s54 offen offset:2048 lds
    v_mfma_f32_32x32x16_bf16 v[80:95], v[52:55], v[164:167], v[80:95]
    s_waitcnt lgkmcnt(6)
    v_mfma_f32_32x32x16_bf16 v[16:31], v[56:59], v[168:171], v[16:31]
    s_add_u32 m0, s39, 3072
    s_add_u32 s54, s54, 22016
    buffer_load_dwordx4 v116, s[96:99], s54 offen offset:0 lds
    v_mfma_f32_32x32x16_bf16 v[96:111], v[60:63], v[168:171], v[96:111]
    v_mfma_f32_32x32x16_bf16 v[80:95], v[64:67], v[168:171], v[80:95]
    buffer_load_dwordx4 v117, s[96:99], s54 offen offset:1024 lds
    s_waitcnt lgkmcnt(0)
    v_mfma_f32_32x32x16_bf16 v[16:31], v[68:71], v[172:175], v[16:31]
    v_mfma_f32_32x32x16_bf16 v[96:111], v[72:75], v[172:175], v[96:111]
    buffer_load_dwordx4 v118, s[96:99], s54 offen offset:2048 lds
    v_mfma_f32_32x32x16_bf16 v[80:95], v[76:79], v[172:175], v[80:95]
    s_waitcnt vmcnt(12)
    s_setprio 3
    s_mov_b64 exec, 1
    ds_add_u32 v3, v11
    s_mov_b64 exec, -1
    s_mov_b32 s62, 1600000
LW_26:
    ds_read_b32 v13, v3 offset:0
    s_waitcnt lgkmcnt(0)
    v_cmp_le_u32 vcc, 16, v13
    s_cbranch_vccnz LWD_27
    s_sleep 1
    s_sub_u32 s62, s62, 1
    s_cbranch_scc0 LW_26
LWD_27:
    s_setprio 0
    ds_read_b64_tr_b16 v[32:33], v121 offset:0
    ds_read_b64_tr_b16 v[34:35], v121 offset:1536
    ds_read_b64_tr_b16 v[36:37], v121 offset:128
    ds_read_b64_tr_b16 v[38:39], v121 offset:1664
    ds_read_b64_tr_b16 v[40:41], v121 offset:256
    ds_read_b64_tr_b16 v[42:43], v121 offset:1792
    ds_read_b64_tr_b16 v[44:45], v121 offset:6144
    ds_read_b64_tr_b16 v[46:47], v121 offset:7680
    ds_read_b64_tr_b16 v[48:49], v121 offset:6272
    ds_read_b64_tr_b16 v[50:51], v121 offset:7808
    ds_read_b64_tr_b16 v[52:53], v121 offset:6400
    ds_read_b64_tr_b16 v[54:55], v121 offset:7936
    s_waitcnt lgkmcnt(6)
    ds_read_b64_tr_b16 v[56:57], v121 offset:12288
    ds_read_b64_tr_b16 v[58:59], v121 offset:13824
    ds_read_b64_tr_b16 v[60:61], v121 offset:12416
    ds_read_b64_tr_b16 v[62:63], v121 offset:13952
    ds_read_b64_tr_b16 v[64:65], v121 offset:12544
    ds_read_b64_tr_b16 v[66:67], v121 offset:14080
    s_waitcnt lgkmcnt(12)
    v_mfma_f32_32x32x16_bf16 v[16:31], v[32:35], v[176:179], v[16:31]
    s_mul_i32 s54, s93, 352256
    s_add_u32 m0, s39, 32768
    s_add_u32 s54, s54, s37
    buffer_load_dwordx4 v116, s[96:99], s54 offen offset:0 lds
    v_mfma_f32_32x32x16_bf16 v[96:111], v[36:39], v[176:179], v[96:111]
    v_mfma_f32_32x32x16_bf16 v[80:95], v[40:43], v[176:179], v[80:95]
    buffer_load_dwordx4 v117, s[96:99], s54 offen offset:1024 lds
    s_waitcnt lgkmcnt(6)
    ds_read_b64_tr_b16 v[68:69], v121 offset:18432
    ds_read_b64_tr_b16 v[70:71], v121 offset:19968
    ds_read_b64_tr_b16 v[72:73], v121 offset:18560
    ds_read_b64_tr_b16 v[74:75], v121 offset:20096
    ds_read_b64_tr_b16 v[76:77], v121 offset:18688
    ds_read_b64_tr_b16 v[78:79], v121 offset:20224
    s_waitcnt lgkmcnt(12)
    v_mfma_f32_32x32x16_bf16 v[16:31], v[44:47], v[180:183], v[16:31]
    v_mfma_f32_32x32x16_bf16 v[96:111], v[48:51], v[180:183], v[96:111]
    buffer_load_dwordx4 v118, s[96:99], s54 offen offset:2048 lds
    v_mfma_f32_32x32x16_bf16 v[80:95], v[52:55], v[180:183], v[80:95]
    s_waitcnt lgkmcnt(6)
    v_mfma_f32_32x32x16_bf16 v[16:31], v[56:59], v[184:187], v[16:31]
    s_add_u32 m0, s39, 35840
    s_add_u32 s54, s54, 22016
    buffer_load_dwordx4 v116, s[96:99], s54 offen offset:0 lds
    v_mfma_f32_32x32x16_bf16 v[96:111], v[60:63], v[184:187], v[96:111]
    v_mfma_f32_32x32x16_bf16 v[80:95], v[64:67], v[184:187], v[80:95]
    buffer_load_dwordx4 v117, s[96:99], s54 offen offset:1024 lds
    s_waitcnt lgkmcnt(0)
    v_mfma_f32_32x32x16_bf16 v[16:31], v[68:71], v[188:191], v[16:31]
    v_mfma_f32_32x32x16_bf16 v[96:111], v[72:75], v[188:191], v[96:111]
    buffer_load_dwordx4 v118, s[96:99], s54 offen offset:2048 lds
    v_mfma_f32_32x32x16_bf16 v[80:95], v[76:79], v[188:191], v[80:95]
    s_waitcnt vmcnt(12)
    s_setprio 3
    s_mov_b64 exec, 1
    ds_add_u32 v3, v11
    s_mov_b64 exec, -1
    s_mov_b32 s62, 1600000
LW_28:
    ds_read_b32 v13, v3 offset:0
    s_waitcnt lgkmcnt(0)
    v_cmp_le_u32 vcc, 20, v13
    s_cbranch_vccnz LWD_29
    s_sleep 1
    s_sub_u32 s62, s62, 1
    s_cbranch_scc0 LW_28
LWD_29:
    s_setprio 0
    ds_read_b64_tr_b16 v[32:33], v121 offset:32768
    ds_read_b64_tr_b16 v[34:35], v121 offset:34304
    ds_read_b64_tr_b16 v[36:37], v121 offset:32896
    ds_read_b64_tr_b16 v[38:39], v121 offset:34432
    ds_read_b64_tr_b16 v[40:41], v121 offset:33024
    ds_read_b64_tr_b16 v[42:43], v121 offset:34560
    ds_read_b64_tr_b16 v[44:45], v121 offset:38912
    ds_read_b64_tr_b16 v[46:47], v121 offset:40448
    ds_read_b64_tr_b16 v[48:49], v121 offset:39040
    ds_read_b64_tr_b16 v[50:51], v121 offset:40576
    ds_read_b64_tr_b16 v[52:53], v121 offset:39168
    ds_read_b64_tr_b16 v[54:55], v121 offset:40704
    s_waitcnt lgkmcnt(6)
    ds_read_b64_tr_b16 v[56:57], v121 offset:45056
    ds_read_b64_tr_b16 v[58:59], v121 offset:46592
    ds_read_b64_tr_b16 v[60:61], v121 offset:45184
    ds_read_b64_tr_b16 v[62:63], v121 offset:46720
    ds_read_b64_tr_b16 v[64:65], v121 offset:45312
    ds_read_b64_tr_b16 v[66:67], v121 offset:46848
    s_waitcnt lgkmcnt(12)
    v_mfma_f32_32x32x16_bf16 v[16:31], v[32:35], v[192:195], v[16:31]
    s_mul_i32 s54, s93, 352256
    s_add_u32 m0, s39, 65536
    s_add_u32 s54, s54, s37
    s_add_u32 s54, s54, 176128
    buffer_load_dwordx4 v116, s[96:99], s54 offen offset:0 lds
    v_mfma_f32_32x32x16_bf16 v[96:111], v[36:39], v[192:195], v[96:111]
    v_mfma_f32_32x32x16_bf16 v[80:95], v[40:43], v[192:195], v[80:95]
    buffer_load_dwordx4 v117, s[96:99], s54 offen offset:1024 lds
    s_waitcnt lgkmcnt(6)
    ds_read_b64_tr_b16 v[68:69], v121 offset:51200
    ds_read_b64_tr_b16 v[70:71], v121 offset:52736
    ds_read_b64_tr_b16 v[72:73], v121 offset:51328
    ds_read_b64_tr_b16 v[74:75], v121 offset:52864
    ds_read_b64_tr_b16 v[76:77], v121 offset:51456
    ds_read_b64_tr_b16 v[78:79], v121 offset:52992
    s_waitcnt lgkmcnt(12)
    v_mfma_f32_32x32x16_bf16 v[16:31], v[44:47], v[196:199], v[16:31]
    v_mfma_f32_32x32x16_bf16 v[96:111], v[48:51], v[196:199], v[96:111]
    buffer_load_dwordx4 v118, s[96:99], s54 offen offset:2048 lds
    v_mfma_f32_32x32x16_bf16 v[80:95], v[52:55], v[196:199], v[80:95]
    s_waitcnt lgkmcnt(6)
    v_mfma_f32_32x32x16_bf16 v[16:31], v[56:59], v[200:203], v[16:31]
    s_add_u32 m0, s39, 68608
    s_add_u32 s54, s54, 22016
    buffer_load_dwordx4 v116, s[96:99], s54 offen offset:0 lds
    v_mfma_f32_32x32x16_bf16 v[96:111], v[60:63], v[200:203], v[96:111]
    v_mfma_f32_32x32x16_bf16 v[80:95], v[64:67], v[200:203], v[80:95]
    buffer_load_dwordx4 v117, s[96:99], s54 offen offset:1024 lds
    s_waitcnt lgkmcnt(0)
    v_mfma_f32_32x32x16_bf16 v[16:31], v[68:71], v[204:207], v[16:31]
    v_mfma_f32_32x32x16_bf16 v[96:111], v[72:75], v[204:207], v[96:111]
    buffer_load_dwordx4 v118, s[96:99], s54 offen offset:2048 lds
    v_mfma_f32_32x32x16_bf16 v[80:95], v[76:79], v[204:207], v[80:95]
    s_mov_b32 s62, 1600000
LW_30:
    ds_read_b32 v13, v3 offset:12
    s_waitcnt lgkmcnt(0)
    v_cmp_le_u32 vcc, 1, v13
    s_cbranch_vccnz LWD_31
    s_sleep 1
    s_sub_u32 s62, s62, 1
    s_cbranch_scc0 LW_30
LWD_31:
    s_lshl_b32 s3, s2, 2
    s_add_u32 s3, s3, s63
    s_mul_i32 s52, s3, 1408
    v_lshl_add_u32 v125, v1, 7, s52
    v_min_u32 v125, 1409020, v125
    s_mov_b64 exec, 0x7ff
    global_load_dword v126, v125, s[74:75]
    s_lshl_b32 s3, s3, 9
    v_lshl_add_u32 v125, v1, 7, s3
    s_mov_b64 exec, 15
    global_load_dword v126, v125, s[68:69]
    s_mov_b64 exec, -1
    s_waitcnt vmcnt(14)
    s_setprio 3
    s_mov_b64 exec, 1
    ds_add_u32 v3, v11
    s_mov_b64 exec, -1
    s_mov_b32 s62, 1600000
LW_32:
    ds_read_b32 v13, v3 offset:0
    s_waitcnt lgkmcnt(0)
    v_cmp_le_u32 vcc, 24, v13
    s_cbranch_vccnz LWD_33
    s_sleep 1
    s_sub_u32 s62, s62, 1
    s_cbranch_scc0 LW_32
LWD_33:
    s_setprio 0
    ds_read_b64_tr_b16 v[32:33], v120 offset:0
    ds_read_b64_tr_b16 v[34:35], v120 offset:1536
    ds_read_b64_tr_b16 v[36:37], v120 offset:128
    ds_read_b64_tr_b16 v[38:39], v120 offset:1664
    ds_read_b64_tr_b16 v[40:41], v120 offset:256
    ds_read_b64_tr_b16 v[42:43], v120 offset:1792
    ds_read_b64_tr_b16 v[44:45], v120 offset:6144
    ds_read_b64_tr_b16 v[46:47], v120 offset:7680
    ds_read_b64_tr_b16 v[48:49], v120 offset:6272
    ds_read_b64_tr_b16 v[50:51], v120 offset:7808
    ds_read_b64_tr_b16 v[52:53], v120 offset:6400
    ds_read_b64_tr_b16 v[54:55], v120 offset:7936
    s_waitcnt lgkmcnt(6)
    ds_read_b64_tr_b16 v[56:57], v120 offset:12288
    ds_read_b64_tr_b16 v[58:59], v120 offset:13824
    ds_read_b64_tr_b16 v[60:61], v120 offset:12416
    ds_read_b64_tr_b16 v[62:63], v120 offset:13952
    ds_read_b64_tr_b16 v[64:65], v120 offset:12544
    ds_read_b64_tr_b16 v[66:67], v120 offset:14080
    s_waitcnt lgkmcnt(12)
    v_mfma_f32_32x32x16_bf16 v[16:31], v[32:35], v[208:211], v[16:31]
    s_add_u32 m0, s31, 147456
    s_add_u32 s54, s36, 393216
    buffer_load_dwordx4 v4, s[20:23], s54 offen lds
    v_mfma_f32_32x32x16_bf16 v[96:111], v[36:39], v[208:211], v[96:111]
    v_mfma_f32_32x32x16_bf16 v[80:95], v[40:43], v[208:211], v[80:95]
    buffer_load_dwordx4 v5, s[20:23], s54 offen offset:1024 lds
    s_waitcnt lgkmcnt(6)
    ds_read_b64_tr_b16 v[68:69], v120 offset:18432
    ds_read_b64_tr_b16 v[70:71], v120 offset:19968
    ds_read_b64_tr_b16 v[72:73], v120 offset:18560
    ds_read_b64_tr_b16 v[74:75], v120 offset:20096
    ds_read_b64_tr_b16 v[76:77], v120 offset:18688
    ds_read_b64_tr_b16 v[78:79], v120 offset:20224
    s_waitcnt lgkmcnt(12)
    v_mfma_f32_32x32x16_bf16 v[16:31], v[44:47], v[212:215], v[16:31]
    s_add_u32 m0, s31, 155648
    s_add_u32 s54, s36, 458752
    buffer_load_dwordx4 v4, s[20:23], s54 offen lds
    v_mfma_f32_32x32x16_bf16 v[96:111], v[48:51], v[212:215], v[96:111]
    v_mfma_f32_32x32x16_bf16 v[80:95], v[52:55], v[212:215], v[80:95]
    buffer_load_dwordx4 v5, s[20:23], s54 offen offset:1024 lds
    s_waitcnt lgkmcnt(6)
    v_mfma_f32_32x32x16_bf16 v[16:31], v[56:59], v[216:219], v[16:31]
    s_add_u32 m0, s31, 131072
    s_add_u32 s54, s36, 1081344
    buffer_load_dwordx4 v4, s[8:11], s54 offen lds
    v_mfma_f32_32x32x16_bf16 v[96:111], v[60:63], v[216:219], v[96:111]
    v_mfma_f32_32x32x16_bf16 v[80:95], v[64:67], v[216:219], v[80:95]
    buffer_load_dwordx4 v5, s[8:11], s54 offen offset:1024 lds
    s_waitcnt lgkmcnt(0)
    v_mfma_f32_32x32x16_bf16 v[16:31], v[68:71], v[220:223], v[16:31]
    s_add_u32 m0, s31, 139264
    s_add_u32 s54, s36, 1146880
    buffer_load_dwordx4 v4, s[8:11], s54 offen lds
    v_mfma_f32_32x32x16_bf16 v[96:111], v[72:75], v[220:223], v[96:111]
    v_mfma_f32_32x32x16_bf16 v[80:95], v[76:79], v[220:223], v[80:95]
    buffer_load_dwordx4 v5, s[8:11], s54 offen offset:1024 lds
    s_waitcnt vmcnt(16)
    s_setprio 3
    s_mov_b64 exec, 1
    ds_add_u32 v3, v11
    s_mov_b64 exec, -1
    s_mov_b32 s62, 1600000
LW_34:
    ds_read_b32 v13, v3 offset:0
    s_waitcnt lgkmcnt(0)
    v_cmp_le_u32 vcc, 28, v13
    s_cbranch_vccnz LWD_35
    s_sleep 1
    s_sub_u32 s62, s62, 1
    s_cbranch_scc0 LW_34
LWD_35:
    s_setprio 0
    ds_read_b64_tr_b16 v[32:33], v120 offset:32768
    ds_read_b64_tr_b16 v[34:35], v120 offset:34304
    ds_read_b64_tr_b16 v[36:37], v120 offset:32896
    ds_read_b64_tr_b16 v[38:39], v120 offset:34432
    ds_read_b64_tr_b16 v[40:41], v120 offset:33024
    ds_read_b64_tr_b16 v[42:43], v120 offset:34560
    ds_read_b64_tr_b16 v[44:45], v120 offset:38912
    ds_read_b64_tr_b16 v[46:47], v120 offset:40448
    ds_read_b64_tr_b16 v[48:49], v120 offset:39040
    ds_read_b64_tr_b16 v[50:51], v120 offset:40576
    ds_read_b64_tr_b16 v[52:53], v120 offset:39168
    ds_read_b64_tr_b16 v[54:55], v120 offset:40704
    s_waitcnt lgkmcnt(6)
    ds_read_b64_tr_b16 v[56:57], v120 offset:45056
    ds_read_b64_tr_b16 v[58:59], v120 offset:46592
    ds_read_b64_tr_b16 v[60:61], v120 offset:45184
    ds_read_b64_tr_b16 v[62:63], v120 offset:46720
    ds_read_b64_tr_b16 v[64:65], v120 offset:45312
    ds_read_b64_tr_b16 v[66:67], v120 offset:46848
    s_waitcnt lgkmcnt(12)
    v_mfma_f32_32x32x16_bf16 v[16:31], v[32:35], v[224:227], v[16:31]
    s_add_u32 m0, s31, 49152
    s_add_u32 s54, s36, 0
    buffer_load_dwordx4 v4, s[20:23], s54 offen lds
    v_mfma_f32_32x32x16_bf16 v[96:111], v[36:39], v[224:227], v[96:111]
    v_mfma_f32_32x32x16_bf16 v[80:95], v[40:43], v[224:227], v[80:95]
    buffer_load_dwordx4 v5, s[20:23], s54 offen offset:1024 lds
    s_waitcnt lgkmcnt(6)
    ds_read_b64_tr_b16 v[68:69], v120 offset:51200
    ds_read_b64_tr_b16 v[70:71], v120 offset:52736
    ds_read_b64_tr_b16 v[72:73], v120 offset:51328
    ds_read_b64_tr_b16 v[74:75], v120 offset:52864
    ds_read_b64_tr_b16 v[76:77], v120 offset:51456
    ds_read_b64_tr_b16 v[78:79], v120 offset:52992
    s_waitcnt lgkmcnt(12)
    v_mfma_f32_32x32x16_bf16 v[16:31], v[44:47], v[228:231], v[16:31]
    s_add_u32 m0, s31, 57344
    s_add_u32 s54, s36, 65536
    buffer_load_dwordx4 v4, s[20:23], s54 offen lds
    v_mfma_f32_32x32x16_bf16 v[96:111], v[48:51], v[228:231], v[96:111]
    v_mfma_f32_32x32x16_bf16 v[80:95], v[52:55], v[228:231], v[80:95]
    buffer_load_dwordx4 v5, s[20:23], s54 offen offset:1024 lds
    s_waitcnt lgkmcnt(6)
    v_mfma_f32_32x32x16_bf16 v[16:31], v[56:59], v[232:235], v[16:31]
    s_add_u32 m0, s31, 32768
    s_add_u32 s54, s36, 0
    buffer_load_dwordx4 v4, s[8:11], s54 offen lds
    v_mfma_f32_32x32x16_bf16 v[96:111], v[60:63], v[232:235], v[96:111]
    v_mfma_f32_32x32x16_bf16 v[80:95], v[64:67], v[232:235], v[80:95]
    buffer_load_dwordx4 v5, s[8:11], s54 offen offset:1024 lds
    s_waitcnt lgkmcnt(0)
    v_mfma_f32_32x32x16_bf16 v[16:31], v[68:71], v[236:239], v[16:31]
    s_add_u32 m0, s31, 40960
    s_add_u32 s54, s36, 65536
    buffer_load_dwordx4 v4, s[8:11], s54 offen lds
    v_mfma_f32_32x32x16_bf16 v[96:111], v[72:75], v[236:239], v[96:111]
    v_mfma_f32_32x32x16_bf16 v[80:95], v[76:79], v[236:239], v[80:95]
    buffer_load_dwordx4 v5, s[8:11], s54 offen offset:1024 lds
    s_waitcnt vmcnt(18)
    s_setprio 3
    s_mov_b64 exec, 1
    ds_add_u32 v3, v11
    s_mov_b64 exec, -1
    s_mov_b32 s62, 1600000
LW_36:
    ds_read_b32 v13, v3 offset:0
    s_waitcnt lgkmcnt(0)
    v_cmp_le_u32 vcc, 32, v13
    s_cbranch_vccnz LWD_37
    s_sleep 1
    s_sub_u32 s62, s62, 1
    s_cbranch_scc0 LW_36
LWD_37:
    s_setprio 0
    ds_read_b64_tr_b16 v[32:33], v121 offset:0
    ds_read_b64_tr_b16 v[34:35], v121 offset:1536
    ds_read_b64_tr_b16 v[36:37], v121 offset:128
    ds_read_b64_tr_b16 v[38:39], v121 offset:1664
    ds_read_b64_tr_b16 v[40:41], v121 offset:256
    ds_read_b64_tr_b16 v[42:43], v121 offset:1792
    ds_read_b64_tr_b16 v[44:45], v121 offset:6144
    ds_read_b64_tr_b16 v[46:47], v121 offset:7680
    ds_read_b64_tr_b16 v[48:49], v121 offset:6272
    ds_read_b64_tr_b16 v[50:51], v121 offset:7808
    ds_read_b64_tr_b16 v[52:53], v121 offset:6400
    ds_read_b64_tr_b16 v[54:55], v121 offset:7936
    s_waitcnt lgkmcnt(6)
    ds_read_b64_tr_b16 v[56:57], v121 offset:12288
    ds_read_b64_tr_b16 v[58:59], v121 offset:13824
    ds_read_b64_tr_b16 v[60:61], v121 offset:12416
    ds_read_b64_tr_b16 v[62:63], v121 offset:13952
    ds_read_b64_tr_b16 v[64:65], v121 offset:12544
    ds_read_b64_tr_b16 v[66:67], v121 offset:14080
    s_waitcnt lgkmcnt(12)
    v_mfma_f32_32x32x16_bf16 v[16:31], v[32:35], v[240:243], v[16:31]
    s_add_u32 m0, s31, 81920
    s_add_u32 s54, s36, 131072
    buffer_load_dwordx4 v4, s[20:23], s54 offen lds
    v_mfma_f32_32x32x16_bf16 v[96:111], v[36:39], v[240:243], v[96:111]
    v_mfma_f32_32x32x16_bf16 v[80:95], v[40:43], v[240:243], v[80:95]
    buffer_load_dwordx4 v5, s[20:23], s54 offen offset:1024 lds
    s_waitcnt lgkmcnt(6)
    ds_read_b64_tr_b16 v[68:69], v121 offset:18432
    ds_read_b64_tr_b16 v[70:71], v121 offset:19968
    ds_read_b64_tr_b16 v[72:73], v121 offset:18560
    ds_read_b64_tr_b16 v[74:75], v121 offset:20096
    ds_read_b64_tr_b16 v[76:77], v121 offset:18688
    ds_read_b64_tr_b16 v[78:79], v121 offset:20224
    s_waitcnt lgkmcnt(12)
    v_mfma_f32_32x32x16_bf16 v[16:31], v[44:47], v[244:247], v[16:31]
    s_add_u32 m0, s31, 90112
    s_add_u32 s54, s36, 196608
    buffer_load_dwordx4 v4, s[20:23], s54 offen lds
    v_mfma_f32_32x32x16_bf16 v[96:111], v[48:51], v[244:247], v[96:111]
    v_mfma_f32_32x32x16_bf16 v[80:95], v[52:55], v[244:247], v[80:95]
    buffer_load_dwordx4 v5, s[20:23], s54 offen offset:1024 lds
    s_waitcnt lgkmcnt(6)
    v_mfma_f32_32x32x16_bf16 v[16:31], v[56:59], v[248:251], v[16:31]
    s_add_u32 m0, s31, 65536
    s_add_u32 s54, s36, 360448
    buffer_load_dwordx4 v4, s[8:11], s54 offen lds
    v_mfma_f32_32x32x16_bf16 v[96:111], v[60:63], v[248:251], v[96:111]
    v_mfma_f32_32x32x16_bf16 v[80:95], v[64:67], v[248:251], v[80:95]
    buffer_load_dwordx4 v5, s[8:11], s54 offen offset:1024 lds
    s_waitcnt lgkmcnt(0)
    v_mfma_f32_32x32x16_bf16 v[16:31], v[68:71], v[252:255], v[16:31]
    s_add_u32 m0, s31, 73728
    s_add_u32 s54, s36, 425984
    buffer_load_dwordx4 v4, s[8:11], s54 offen lds
    v_mfma_f32_32x32x16_bf16 v[96:111], v[72:75], v[252:255], v[96:111]
    v_mfma_f32_32x32x16_bf16 v[80:95], v[76:79], v[252:255], v[80:95]
    buffer_load_dwordx4 v5, s[8:11], s54 offen offset:1024 lds
    s_setprio 0
    s_nop 10
    v_cvt_pk_bf16_f32 v32, v16, v17
    v_cvt_pk_bf16_f32 v33, v18, v19
    v_cvt_pk_bf16_f32 v34, v20, v21
    v_cvt_pk_bf16_f32 v35, v22, v23
    v_cvt_pk_bf16_f32 v36, v24, v25
    v_cvt_pk_bf16_f32 v37, v26, v27
    v_cvt_pk_bf16_f32 v38, v28, v29
    v_cvt_pk_bf16_f32 v39, v30, v31
    v_pk_max_i16 v32, v32, 0
    v_pk_max_i16 v33, v33, 0
    v_pk_max_i16 v34, v34, 0
    v_pk_max_i16 v35, v35, 0
    v_pk_max_i16 v36, v36, 0
    v_pk_max_i16 v37, v37, 0
    v_pk_max_i16 v38, v38, 0
    v_pk_max_i16 v39, v39, 0
    buffer_store_dwordx4 v[32:35], v2, s[16:19], s57 offen sc1
    buffer_store_dwordx4 v[36:39], v2, s[16:19], s57 offen offset:2048 sc1
    s_add_u32 s57, s57, 8192
    v_cvt_pk_bf16_f32 v40, v96, v97
    v_cvt_pk_bf16_f32 v41, v98, v99
    v_cvt_pk_bf16_f32 v42, v100, v101
    v_cvt_pk_bf16_f32 v43, v102, v103
    v_cvt_pk_bf16_f32 v44, v104, v105
    v_cvt_pk_bf16_f32 v45, v106, v107
    v_cvt_pk_bf16_f32 v46, v108, v109
    v_cvt_pk_bf16_f32 v47, v110, v111
    v_pk_max_i16 v40, v40, 0
    v_pk_max_i16 v41, v41, 0
    v_pk_max_i16 v42, v42, 0
    v_pk_max_i16 v43, v43, 0
    v_pk_max_i16 v44, v44, 0
    v_pk_max_i16 v45, v45, 0
    v_pk_max_i16 v46, v46, 0
    v_pk_max_i16 v47, v47, 0
    buffer_store_dwordx4 v[40:43], v2, s[16:19], s57 offen sc1
    buffer_store_dwordx4 v[44:47], v2, s[16:19], s57 offen offset:2048 sc1
    s_add_u32 s57, s57, 8192
    v_cvt_pk_bf16_f32 v48, v80, v81
    v_cvt_pk_bf16_f32 v49, v82, v83
    v_cvt_pk_bf16_f32 v50, v84, v85
    v_cvt_pk_bf16_f32 v51, v86, v87
    v_cvt_pk_bf16_f32 v52, v88, v89
    v_cvt_pk_bf16_f32 v53, v90, v91
    v_cvt_pk_bf16_f32 v54, v92, v93
    v_cvt_pk_bf16_f32 v55, v94, v95
    v_pk_max_i16 v48, v48, 0
    v_pk_max_i16 v49, v49, 0
    v_pk_max_i16 v50, v50, 0
    v_pk_max_i16 v51, v51, 0
    v_pk_max_i16 v52, v52, 0
    v_pk_max_i16 v53, v53, 0
    v_pk_max_i16 v54, v54, 0
    v_pk_max_i16 v55, v55, 0
    buffer_store_dwordx4 v[48:51], v2, s[16:19], s57 offen sc1
    buffer_store_dwordx4 v[52:55], v2, s[16:19], s57 offen offset:2048 sc1
    s_add_u32 s57, s57, 8192
    s_setprio 0
    s_setprio 3
    s_mov_b64 exec, 1
    ds_add_u32 v3, v11
    s_mov_b64 exec, -1
    s_mov_b32 s62, 1600000
LW_38:
    ds_read_b32 v13, v3 offset:0
    s_waitcnt lgkmcnt(0)
    v_cmp_le_u32 vcc, 36, v13
    s_cbranch_vccnz LWD_39
    s_sleep 1
    s_sub_u32 s62, s62, 1
    s_cbranch_scc0 LW_38
LWD_39:
    s_setprio 0
    s_waitcnt vmcnt(0)
    v_mov_b32 v13, s28
    v_lshrrev_b32 v14, 2, v2
    v_add_u32 v14, 131072, v14
    s_mov_b32 exec_lo, 0xffffffff
    s_mov_b32 exec_hi, 0
    buffer_store_dword v13, v14, s[12:15], s29 offen sc1
    s_mov_b64 exec, -1
    s_add_u32 m0, s31, 114688
    s_add_u32 s54, s36, 262144
    buffer_load_dwordx4 v4, s[20:23], s54 offen lds
    buffer_load_dwordx4 v5, s[20:23], s54 offen offset:1024 lds
    s_waitcnt vmcnt(4)
    s_add_u32 m0, s31, 122880
    s_add_u32 s54, s36, 327680
    buffer_load_dwordx4 v4, s[20:23], s54 offen lds
    buffer_load_dwordx4 v5, s[20:23], s54 offen offset:1024 lds
    s_waitcnt vmcnt(4)
    s_add_u32 m0, s31, 98304
    s_add_u32 s54, s36, 720896
    buffer_load_dwordx4 v4, s[8:11], s54 offen lds
    buffer_load_dwordx4 v5, s[8:11], s54 offen offset:1024 lds
    s_waitcnt vmcnt(4)
    s_add_u32 m0, s31, 106496
    s_add_u32 s54, s36, 786432
    buffer_load_dwordx4 v4, s[8:11], s54 offen lds
    buffer_load_dwordx4 v5, s[8:11], s54 offen offset:1024 lds
    s_waitcnt vmcnt(4)
    s_waitcnt vmcnt(0)
    s_setprio 3
    s_mov_b64 exec, 1
    ds_add_u32 v3, v11
    s_mov_b64 exec, -1
    s_mov_b32 s62, 1600000
LW_40:
    ds_read_b32 v13, v3 offset:0
    s_waitcnt lgkmcnt(0)
    v_cmp_le_u32 vcc, 40, v13
    s_cbranch_vccnz LWD_41
    s_sleep 1
    s_sub_u32 s62, s62, 1
    s_cbranch_scc0 LW_40
LWD_41:
    s_setprio 0
    ds_read_b64_tr_b16 v[192:193], v6 offset:16384
    ds_read_b64_tr_b16 v[194:195], v6 offset:17408
    ds_read_b64_tr_b16 v[196:197], v7 offset:16384
    ds_read_b64_tr_b16 v[198:199], v7 offset:17408
    s_waitcnt lgkmcnt(8)
    ds_read_b64_tr_b16 v[200:201], v6 offset:18432
    ds_read_b64_tr_b16 v[202:203], v6 offset:19456
    ds_read_b64_tr_b16 v[204:205], v7 offset:18432
    ds_read_b64_tr_b16 v[206:207], v7 offset:19456
    s_waitcnt lgkmcnt(8)
    ds_read_b64_tr_b16 v[208:209], v6 offset:20480
    ds_read_b64_tr_b16 v[210:211], v6 offset:21504
    ds_read_b64_tr_b16 v[212:213], v7 offset:20480
    ds_read_b64_tr_b16 v[214:215], v7 offset:21504
    s_waitcnt lgkmcnt(8)
    ds_read_b64_tr_b16 v[216:217], v6 offset:22528
    ds_read_b64_tr_b16 v[218:219], v6 offset:23552
    ds_read_b64_tr_b16 v[220:221], v7 offset:22528
    ds_read_b64_tr_b16 v[222:223], v7 offset:23552
    s_waitcnt lgkmcnt(8)
    ds_read_b64_tr_b16 v[224:225], v6 offset:24576
    ds_read_b64_tr_b16 v[226:227], v6 offset:25600
    ds_read_b64_tr_b16 v[228:229], v7 offset:24576
    ds_read_b64_tr_b16 v[230:231], v7 offset:25600
    s_waitcnt lgkmcnt(8)
    ds_read_b64_tr_b16 v[232:233], v6 offset:26624
    ds_read_b64_tr_b16 v[234:235], v6 offset:27648
    ds_read_b64_tr_b16 v[236:237], v7 offset:26624
    ds_read_b64_tr_b16 v[238:239], v7 offset:27648
    s_waitcnt lgkmcnt(8)
    ds_read_b64_tr_b16 v[240:241], v6 offset:28672
    ds_read_b64_tr_b16 v[242:243], v6 offset:29696
    ds_read_b64_tr_b16 v[244:245], v7 offset:28672
    ds_read_b64_tr_b16 v[246:247], v7 offset:29696
    s_waitcnt lgkmcnt(8)
    ds_read_b64_tr_b16 v[248:249], v6 offset:30720
    ds_read_b64_tr_b16 v[250:251], v6 offset:31744
    ds_read_b64_tr_b16 v[252:253], v7 offset:30720
    ds_read_b64_tr_b16 v[254:255], v7 offset:31744
    s_waitcnt lgkmcnt(8)
    s_waitcnt lgkmcnt(0)
    s_add_u32 m0, s61, 16384
    s_add_u32 s52, s33, 131072
    buffer_load_dwordx4 v4, s[8:11], s52 offen lds
    buffer_load_dwordx4 v5, s[8:11], s52 offen offset:1024 lds
    s_waitcnt vmcnt(4)
    s_add_u32 m0, s61, 18432
    s_add_u32 s52, s33, 147456
    buffer_load_dwordx4 v4, s[8:11], s52 offen lds
    buffer_load_dwordx4 v5, s[8:11], s52 offen offset:1024 lds
    s_waitcnt vmcnt(4)
    s_add_u32 m0, s61, 20480
    s_add_u32 s52, s33, 163840
    buffer_load_dwordx4 v4, s[8:11], s52 offen lds
    buffer_load_dwordx4 v5, s[8:11], s52 offen offset:1024 lds
    s_waitcnt vmcnt(4)
    s_add_u32 m0, s61, 22528
    s_add_u32 s52, s33, 180224
    buffer_load_dwordx4 v4, s[8:11], s52 offen lds
    buffer_load_dwordx4 v5, s[8:11], s52 offen offset:1024 lds
    s_waitcnt vmcnt(4)
    s_add_u32 m0, s61, 24576
    s_add_u32 s52, s33, 196608
    buffer_load_dwordx4 v4, s[8:11], s52 offen lds
    buffer_load_dwordx4 v5, s[8:11], s52 offen offset:1024 lds
    s_waitcnt vmcnt(4)
    s_add_u32 m0, s61, 26624
    s_add_u32 s52, s33, 212992
    buffer_load_dwordx4 v4, s[8:11], s52 offen lds
    buffer_load_dwordx4 v5, s[8:11], s52 offen offset:1024 lds
    s_waitcnt vmcnt(4)
    s_add_u32 m0, s61, 28672
    s_add_u32 s52, s33, 229376
    buffer_load_dwordx4 v4, s[8:11], s52 offen lds
    buffer_load_dwordx4 v5, s[8:11], s52 offen offset:1024 lds
    s_waitcnt vmcnt(4)
    s_add_u32 m0, s61, 30720
    s_add_u32 s52, s33, 245760
    buffer_load_dwordx4 v4, s[8:11], s52 offen lds
    buffer_load_dwordx4 v5, s[8:11], s52 offen offset:1024 lds
    s_waitcnt vmcnt(4)
    s_lshl_b32 s30, s25, 12
    s_add_u32 s30, s30, 131072
    s_mov_b32 s62, 200000
LP_42:
    buffer_load_dword v80, v8, s[12:15], s30 offen sc1
    s_waitcnt vmcnt(0)
    v_cmp_ne_u32 vcc, s28, v80
    s_cbranch_vccz LPD_43
    s_sleep 4
    s_sub_u32 s62, s62, 1
    s_cbranch_scc0 LP_42
LPD_43:
    s_setprio 0
    s_add_u32 s52, s34, 0
    buffer_load_dwordx4 v[104:107], v2, s[16:19], s52 offen sc1
    buffer_load_dwordx4 v[108:111], v2, s[16:19], s52 offen offset:1024 sc1
    s_add_u32 s52, s34, 2048
    buffer_load_dwordx4 v[112:115], v2, s[16:19], s52 offen sc1
    buffer_load_dwordx4 v[116:119], v2, s[16:19], s52 offen offset:1024 sc1
    s_add_u32 s52, s34, 4096
    buffer_load_dwordx4 v[120:123], v2, s[16:19], s52 offen sc1
    buffer_load_dwordx4 v[124:127], v2, s[16:19], s52 offen offset:1024 sc1
    s_add_u32 s52, s34, 6144
    buffer_load_dwordx4 v[128:131], v2, s[16:19], s52 offen sc1
    buffer_load_dwordx4 v[132:135], v2, s[16:19], s52 offen offset:1024 sc1
    ds_read_b64_tr_b16 v[80:81], v6 offset:0
    ds_read_b64_tr_b16 v[82:83], v6 offset:1024
    ds_read_b64_tr_b16 v[84:85], v7 offset:0
    ds_read_b64_tr_b16 v[86:87], v7 offset:1024
    ds_read_b64_tr_b16 v[88:89], v6 offset:2048
    ds_read_b64_tr_b16 v[90:91], v6 offset:3072
    ds_read_b64_tr_b16 v[92:93], v7 offset:2048
    ds_read_b64_tr_b16 v[94:95], v7 offset:3072
    s_add_u32 s52, s34, 8192
    buffer_load_dwordx4 v[136:139], v2, s[16:19], s52 offen sc1
    buffer_load_dwordx4 v[140:143], v2, s[16:19], s52 offen offset:1024 sc1
    ds_read_b64_tr_b16 v[96:97], v6 offset:4096
    ds_read_b64_tr_b16 v[98:99], v6 offset:5120
    ds_read_b64_tr_b16 v[100:101], v7 offset:4096
    ds_read_b64_tr_b16 v[102:103], v7 offset:5120
    s_waitcnt vmcnt(8)
    s_waitcnt lgkmcnt(8)
    v_mfma_f32_32x32x16_bf16 v[16:31], v[80:83], v[104:107], 0
    v_mfma_f32_32x32x16_bf16 v[32:47], v[84:87], v[104:107], 0
    v_mfma_f32_32x32x16_bf16 v[48:63], v[80:83], v[108:111], 0
    v_mfma_f32_32x32x16_bf16 v[64:79], v[84:87], v[108:111], 0
    s_add_u32 s52, s34, 10240
    buffer_load_dwordx4 v[144:147], v2, s[16:19], s52 offen sc1
    buffer_load_dwordx4 v[148:151], v2, s[16:19], s52 offen offset:1024 sc1
    s_add_u32 m0, s61, 0
    s_add_u32 s52, s33, 262144
    buffer_load_dwordx4 v4, s[8:11], s52 offen lds
    buffer_load_dwordx4 v5, s[8:11], s52 offen offset:1024 lds
    ds_read_b64_tr_b16 v[80:81], v6 offset:6144
    ds_read_b64_tr_b16 v[82:83], v6 offset:7168
    ds_read_b64_tr_b16 v[84:85], v7 offset:6144
    ds_read_b64_tr_b16 v[86:87], v7 offset:7168
    s_waitcnt vmcnt(10)
    s_waitcnt lgkmcnt(8)
    v_mfma_f32_32x32x16_bf16 v[16:31], v[88:91], v[112:115], v[16:31]
    v_mfma_f32_32x32x16_bf16 v[32:47], v[92:95], v[112:115], v[32:47]
    v_mfma_f32_32x32x16_bf16 v[48:63], v[88:91], v[116:119], v[48:63]
    v_mfma_f32_32x32x16_bf16 v[64:79], v[92:95], v[116:119], v[64:79]
    s_add_u32 s52, s34, 12288
    buffer_load_dwordx4 v[152:155], v2, s[16:19], s52 offen sc1
    buffer_load_dwordx4 v[156:159], v2, s[16:19], s52 offen offset:1024 sc1
    s_add_u32 m0, s61, 2048
    s_add_u32 s52, s33, 278528
    buffer_load_dwordx4 v4, s[8:11], s52 offen lds
    buffer_load_dwordx4 v5, s[8:11], s52 offen offset:1024 lds
    ds_read_b64_tr_b16 v[88:89], v6 offset:8192
    ds_read_b64_tr_b16 v[90:91], v6 offset:9216
    ds_read_b64_tr_b16 v[92:93], v7 offset:8192
    ds_read_b64_tr_b16 v[94:95], v7 offset:9216
    s_waitcnt vmcnt(12)
    s_waitcnt lgkmcnt(8)
    v_mfma_f32_32x32x16_bf16 v[16:31], v[96:99], v[120:123], v[16:31]
    v_mfma_f32_32x32x16_bf16 v[32:47], v[100:103], v[120:123], v[32:47]
    v_mfma_f32_32x32x16_bf16 v[48:63], v[96:99], v[124:127], v[48:63]
    v_mfma_f32_32x32x16_bf16 v[64:79], v[100:103], v[124:127], v[64:79]
    s_add_u32 s52, s34, 14336
    buffer_load_dwordx4 v[160:163], v2, s[16:19], s52 offen sc1
    buffer_load_dwordx4 v[164:167], v2, s[16:19], s52 offen offset:1024 sc1
    s_add_u32 m0, s61, 4096
    s_add_u32 s52, s33, 294912
    buffer_load_dwordx4 v4, s[8:11], s52 offen lds
    buffer_load_dwordx4 v5, s[8:11], s52 offen offset:1024 lds
    ds_read_b64_tr_b16 v[96:97], v6 offset:10240
    ds_read_b64_tr_b16 v[98:99], v6 offset:11264
    ds_read_b64_tr_b16 v[100:101], v7 offset:10240
    ds_read_b64_tr_b16 v[102:103], v7 offset:11264
    s_waitcnt vmcnt(14)
    s_waitcnt lgkmcnt(8)
    v_mfma_f32_32x32x16_bf16 v[16:31], v[80:83], v[128:131], v[16:31]
    v_mfma_f32_32x32x16_bf16 v[32:47], v[84:87], v[128:131], v[32:47]
    v_mfma_f32_32x32x16_bf16 v[48:63], v[80:83], v[132:135], v[48:63]
    v_mfma_f32_32x32x16_bf16 v[64:79], v[84:87], v[132:135], v[64:79]
    s_add_u32 s52, s34, 16384
    buffer_load_dwordx4 v[168:171], v2, s[16:19], s52 offen sc1
    buffer_load_dwordx4 v[172:175], v2, s[16:19], s52 offen offset:1024 sc1
    s_add_u32 m0, s61, 6144
    s_add_u32 s52, s33, 311296
    buffer_load_dwordx4 v4, s[8:11], s52 offen lds
    buffer_load_dwordx4 v5, s[8:11], s52 offen offset:1024 lds
    ds_read_b64_tr_b16 v[80:81], v6 offset:12288
    ds_read_b64_tr_b16 v[82:83], v6 offset:13312
    ds_read_b64_tr_b16 v[84:85], v7 offset:12288
    ds_read_b64_tr_b16 v[86:87], v7 offset:13312
    s_waitcnt vmcnt(16)
    s_waitcnt lgkmcnt(8)
    v_mfma_f32_32x32x16_bf16 v[16:31], v[88:91], v[136:139], v[16:31]
    v_mfma_f32_32x32x16_bf16 v[32:47], v[92:95], v[136:139], v[32:47]
    v_mfma_f32_32x32x16_bf16 v[48:63], v[88:91], v[140:143], v[48:63]
    v_mfma_f32_32x32x16_bf16 v[64:79], v[92:95], v[140:143], v[64:79]
    s_add_u32 s52, s34, 18432
    buffer_load_dwordx4 v[176:179], v2, s[16:19], s52 offen sc1
    buffer_load_dwordx4 v[180:183], v2, s[16:19], s52 offen offset:1024 sc1
    s_add_u32 m0, s61, 8192
    s_add_u32 s52, s33, 327680
    buffer_load_dwordx4 v4, s[8:11], s52 offen lds
    buffer_load_dwordx4 v5, s[8:11], s52 offen offset:1024 lds
    ds_read_b64_tr_b16 v[88:89], v6 offset:14336
    ds_read_b64_tr_b16 v[90:91], v6 offset:15360
    ds_read_b64_tr_b16 v[92:93], v7 offset:14336
    ds_read_b64_tr_b16 v[94:95], v7 offset:15360
    s_waitcnt vmcnt(18)
    s_waitcnt lgkmcnt(8)
    v_mfma_f32_32x32x16_bf16 v[16:31], v[96:99], v[144:147], v[16:31]
    v_mfma_f32_32x32x16_bf16 v[32:47], v[100:103], v[144:147], v[32:47]
    v_mfma_f32_32x32x16_bf16 v[48:63], v[96:99], v[148:151], v[48:63]
    v_mfma_f32_32x32x16_bf16 v[64:79], v[100:103], v[148:151], v[64:79]
    s_add_u32 s52, s34, 20480
    buffer_load_dwordx4 v[184:187], v2, s[16:19], s52 offen sc1
    buffer_load_dwordx4 v[188:191], v2, s[16:19], s52 offen offset:1024 sc1
    s_waitcnt vmcnt(4)
    s_add_u32 s52, s34, 22528
    buffer_load_dwordx4 v[104:107], v2, s[16:19], s52 offen sc1
    buffer_load_dwordx4 v[108:111], v2, s[16:19], s52 offen offset:1024 sc1
    s_waitcnt vmcnt(4)
    s_add_u32 s52, s34, 24576
    buffer_load_dwordx4 v[112:115], v2, s[16:19], s52 offen sc1
    buffer_load_dwordx4 v[116:119], v2, s[16:19], s52 offen offset:1024 sc1
    s_waitcnt vmcnt(4)
    s_add_u32 s52, s34, 26624
    buffer_load_dwordx4 v[120:123], v2, s[16:19], s52 offen sc1
    buffer_load_dwordx4 v[124:127], v2, s[16:19], s52 offen offset:1024 sc1
    s_waitcnt vmcnt(4)
    s_add_u32 s52, s34, 28672
    buffer_load_dwordx4 v[128:131], v2, s[16:19], s52 offen sc1
    buffer_load_dwordx4 v[132:135], v2, s[16:19], s52 offen offset:1024 sc1
    s_waitcnt vmcnt(4)
    s_add_u32 s52, s34, 30720
    buffer_load_dwordx4 v[136:139], v2, s[16:19], s52 offen sc1
    buffer_load_dwordx4 v[140:143], v2, s[16:19], s52 offen offset:1024 sc1
    s_waitcnt vmcnt(4)
    s_add_u32 s52, s34, 32768
    buffer_load_dwordx4 v[144:147], v2, s[16:19], s52 offen sc1
    buffer_load_dwordx4 v[148:151], v2, s[16:19], s52 offen offset:1024 sc1
    s_waitcnt vmcnt(4)
    s_lshl_b32 s38, s25, 16
    s_lshl_b32 s53, s63, 14
    s_add_u32 s38, s38, s53
    s_add_u32 s38, s38, 15728640
    s_and_b32 s54, s26, 1
    s_lshl_b32 s53, s54, 10
    s_add_u32 s38, s38, s53
    s_lshl_b32 s37, s54, 13
    s_lshl_b32 s30, s25, 12
    s_lshl_b32 s53, s63, 10
    s_add_u32 s30, s30, s53
    s_add_u32 s30, s30, 262144
    v_and_b32 v8, 0x380, v8
    v_and_b32 v13, 31, v1
    v_lshrrev_b32 v14, 5, v1
    v_xor_b32 v14, v14, v1
    v_and_b32 v14, 15, v14
    v_lshlrev_b32 v9, 8, v13
    v_lshl_add_u32 v9, v14, 4, v9
    v_add_u32 v9, s61, v9
    s_lshl_b32 s52, s63, 2
    v_add_u32 v10, s52, v3
    s_mov_b32 s62, 1600000
LW_44:
    ds_read_b32 v13, v10 offset:32
    s_waitcnt lgkmcnt(0)
    v_cmp_le_u32 vcc, 1, v13
    s_cbranch_vccnz LWD_45
    s_sleep 4
    s_sub_u32 s62, s62, 1
    s_cbranch_scc0 LW_44
LWD_45:
    s_setprio 1
    s_add_u32 m0, s61, 10240
    s_add_u32 s52, s33, 344064
    buffer_load_dwordx4 v4, s[8:11], s52 offen lds
    buffer_load_dwordx4 v5, s[8:11], s52 offen offset:1024 lds
    ds_read_b64_tr_b16 v[96:97], v6 offset:16384
    ds_read_b64_tr_b16 v[98:99], v6 offset:17408
    ds_read_b64_tr_b16 v[100:101], v7 offset:16384
    ds_read_b64_tr_b16 v[102:103], v7 offset:17408
    s_waitcnt vmcnt(30)
    s_waitcnt lgkmcnt(8)
    v_mfma_f32_32x32x16_bf16 v[16:31], v[80:83], v[152:155], v[16:31]
    v_mfma_f32_32x32x16_bf16 v[32:47], v[84:87], v[152:155], v[32:47]
    v_mfma_f32_32x32x16_bf16 v[48:63], v[80:83], v[156:159], v[48:63]
    v_mfma_f32_32x32x16_bf16 v[64:79], v[84:87], v[156:159], v[64:79]
    s_add_u32 s52, s34, 34816
    buffer_load_dwordx4 v[152:155], v2, s[16:19], s52 offen sc1
    buffer_load_dwordx4 v[156:159], v2, s[16:19], s52 offen offset:1024 sc1
    ds_read_b64_tr_b16 v[80:81], v6 offset:18432
    ds_read_b64_tr_b16 v[82:83], v6 offset:19456
    ds_read_b64_tr_b16 v[84:85], v7 offset:18432
    ds_read_b64_tr_b16 v[86:87], v7 offset:19456
    s_waitcnt vmcnt(28)
    s_waitcnt lgkmcnt(8)
    v_mfma_f32_32x32x16_bf16 v[16:31], v[88:91], v[160:163], v[16:31]
    v_mfma_f32_32x32x16_bf16 v[32:47], v[92:95], v[160:163], v[32:47]
    v_mfma_f32_32x32x16_bf16 v[48:63], v[88:91], v[164:167], v[48:63]
    v_mfma_f32_32x32x16_bf16 v[64:79], v[92:95], v[164:167], v[64:79]
    s_add_u32 s52, s34, 36864
    buffer_load_dwordx4 v[160:163], v2, s[16:19], s52 offen sc1
    buffer_load_dwordx4 v[164:167], v2, s[16:19], s52 offen offset:1024 sc1
    ds_read_b64_tr_b16 v[88:89], v6 offset:20480
    ds_read_b64_tr_b16 v[90:91], v6 offset:21504
    ds_read_b64_tr_b16 v[92:93], v7 offset:20480
    ds_read_b64_tr_b16 v[94:95], v7 offset:21504
    s_waitcnt vmcnt(26)
    s_waitcnt lgkmcnt(8)
    v_mfma_f32_32x32x16_bf16 v[16:31], v[96:99], v[168:171], v[16:31]
    v_mfma_f32_32x32x16_bf16 v[32:47], v[100:103], v[168:171], v[32:47]
    v_mfma_f32_32x32x16_bf16 v[48:63], v[96:99], v[172:175], v[48:63]
    v_mfma_f32_32x32x16_bf16 v[64:79], v[100:103], v[172:175], v[64:79]
    s_add_u32 s52, s34, 38912
    buffer_load_dwordx4 v[168:171], v2, s[16:19], s52 offen sc1
    buffer_load_dwordx4 v[172:175], v2, s[16:19], s52 offen offset:1024 sc1
    ds_read_b64_tr_b16 v[96:97], v6 offset:22528
    ds_read_b64_tr_b16 v[98:99], v6 offset:23552
    ds_read_b64_tr_b16 v[100:101], v7 offset:22528
    ds_read_b64_tr_b16 v[102:103], v7 offset:23552
    s_waitcnt vmcnt(24)
    s_waitcnt lgkmcnt(8)
    v_mfma_f32_32x32x16_bf16 v[16:31], v[80:83], v[176:179], v[16:31]
    v_mfma_f32_32x32x16_bf16 v[32:47], v[84:87], v[176:179], v[32:47]
    v_mfma_f32_32x32x16_bf16 v[48:63], v[80:83], v[180:183], v[48:63]
    v_mfma_f32_32x32x16_bf16 v[64:79], v[84:87], v[180:183], v[64:79]
    s_add_u32 s52, s34, 40960
    buffer_load_dwordx4 v[176:179], v2, s[16:19], s52 offen sc1
    buffer_load_dwordx4 v[180:183], v2, s[16:19], s52 offen offset:1024 sc1
    ds_read_b64_tr_b16 v[80:81], v6 offset:24576
    ds_read_b64_tr_b16 v[82:83], v6 offset:25600
    ds_read_b64_tr_b16 v[84:85], v7 offset:24576
    ds_read_b64_tr_b16 v[86:87], v7 offset:25600
    s_waitcnt vmcnt(22)
    s_waitcnt lgkmcnt(8)
    v_mfma_f32_32x32x16_bf16 v[16:31], v[88:91], v[184:187], v[16:31]
    v_mfma_f32_32x32x16_bf16 v[32:47], v[92:95], v[184:187], v[32:47]
    v_mfma_f32_32x32x16_bf16 v[48:63], v[88:91], v[188:191], v[48:63]
    v_mfma_f32_32x32x16_bf16 v[64:79], v[92:95], v[188:191], v[64:79]
    s_add_u32 s52, s34, 43008
    buffer_load_dwordx4 v[184:187], v2, s[16:19], s52 offen sc1
    buffer_load_dwordx4 v[188:191], v2, s[16:19], s52 offen offset:1024 sc1
    ds_read_b64_tr_b16 v[88:89], v6 offset:26624
    ds_read_b64_tr_b16 v[90:91], v6 offset:27648
    ds_read_b64_tr_b16 v[92:93], v7 offset:26624
    ds_read_b64_tr_b16 v[94:95], v7 offset:27648
    s_waitcnt vmcnt(22)
    s_waitcnt lgkmcnt(8)
    v_mfma_f32_32x32x16_bf16 v[16:31], v[96:99], v[104:107], v[16:31]
    v_mfma_f32_32x32x16_bf16 v[32:47], v[100:103], v[104:107], v[32:47]
    v_mfma_f32_32x32x16_bf16 v[48:63], v[96:99], v[108:111], v[48:63]
    v_mfma_f32_32x32x16_bf16 v[64:79], v[100:103], v[108:111], v[64:79]
    ds_read_b64_tr_b16 v[96:97], v6 offset:28672
    ds_read_b64_tr_b16 v[98:99], v6 offset:29696
    ds_read_b64_tr_b16 v[100:101], v7 offset:28672
    ds_read_b64_tr_b16 v[102:103], v7 offset:29696
    s_waitcnt vmcnt(20)
    s_waitcnt lgkmcnt(8)
    v_mfma_f32_32x32x16_bf16 v[16:31], v[80:83], v[112:115], v[16:31]
    v_mfma_f32_32x32x16_bf16 v[32:47], v[84:87], v[112:115], v[32:47]
    v_mfma_f32_32x32x16_bf16 v[48:63], v[80:83], v[116:119], v[48:63]
    v_mfma_f32_32x32x16_bf16 v[64:79], v[84:87], v[116:119], v[64:79]
    ds_read_b64_tr_b16 v[80:81], v6 offset:30720
    ds_read_b64_tr_b16 v[82:83], v6 offset:31744
    ds_read_b64_tr_b16 v[84:85], v7 offset:30720
    ds_read_b64_tr_b16 v[86:87], v7 offset:31744
    s_waitcnt vmcnt(18)
    s_waitcnt lgkmcnt(8)
    v_mfma_f32_32x32x16_bf16 v[16:31], v[88:91], v[120:123], v[16:31]
    v_mfma_f32_32x32x16_bf16 v[32:47], v[92:95], v[120:123], v[32:47]
    v_mfma_f32_32x32x16_bf16 v[48:63], v[88:91], v[124:127], v[48:63]
    v_mfma_f32_32x32x16_bf16 v[64:79], v[92:95], v[124:127], v[64:79]
    s_waitcnt vmcnt(42)
    ds_read_b64_tr_b16 v[88:89], v6 offset:0
    ds_read_b64_tr_b16 v[90:91], v6 offset:1024
    ds_read_b64_tr_b16 v[92:93], v7 offset:0
    ds_read_b64_tr_b16 v[94:95], v7 offset:1024
    s_waitcnt vmcnt(16)
    s_waitcnt lgkmcnt(8)
    v_mfma_f32_32x32x16_bf16 v[16:31], v[96:99], v[128:131], v[16:31]
    v_mfma_f32_32x32x16_bf16 v[32:47], v[100:103], v[128:131], v[32:47]
    v_mfma_f32_32x32x16_bf16 v[48:63], v[96:99], v[132:135], v[48:63]
    v_mfma_f32_32x32x16_bf16 v[64:79], v[100:103], v[132:135], v[64:79]
    s_waitcnt vmcnt(38)
    ds_read_b64_tr_b16 v[96:97], v6 offset:2048
    ds_read_b64_tr_b16 v[98:99], v6 offset:3072
    ds_read_b64_tr_b16 v[100:101], v7 offset:2048
    ds_read_b64_tr_b16 v[102:103], v7 offset:3072
    s_waitcnt vmcnt(14)
    s_waitcnt lgkmcnt(8)
    v_mfma_f32_32x32x16_bf16 v[16:31], v[80:83], v[136:139], v[16:31]
    v_mfma_f32_32x32x16_bf16 v[32:47], v[84:87], v[136:139], v[32:47]
    v_mfma_f32_32x32x16_bf16 v[48:63], v[80:83], v[140:143], v[48:63]
    v_mfma_f32_32x32x16_bf16 v[64:79], v[84:87], v[140:143], v[64:79]
    s_waitcnt vmcnt(34)
    ds_read_b64_tr_b16 v[80:81], v6 offset:4096
    ds_read_b64_tr_b16 v[82:83], v6 offset:5120
    ds_read_b64_tr_b16 v[84:85], v7 offset:4096
    ds_read_b64_tr_b16 v[86:87], v7 offset:5120
    s_waitcnt vmcnt(12)
    s_waitcnt lgkmcnt(8)
    v_mfma_f32_32x32x16_bf16 v[16:31], v[88:91], v[144:147], v[16:31]
    v_mfma_f32_32x32x16_bf16 v[32:47], v[92:95], v[144:147], v[32:47]
    v_mfma_f32_32x32x16_bf16 v[48:63], v[88:91], v[148:151], v[48:63]
    v_mfma_f32_32x32x16_bf16 v[64:79], v[92:95], v[148:151], v[64:79]
    s_waitcnt vmcnt(30)
    ds_read_b64_tr_b16 v[88:89], v6 offset:6144
    ds_read_b64_tr_b16 v[90:91], v6 offset:7168
    ds_read_b64_tr_b16 v[92:93], v7 offset:6144
    ds_read_b64_tr_b16 v[94:95], v7 offset:7168
    s_waitcnt vmcnt(8)
    s_waitcnt lgkmcnt(8)
    v_mfma_f32_32x32x16_bf16 v[16:31], v[96:99], v[152:155], v[16:31]
    v_mfma_f32_32x32x16_bf16 v[32:47], v[100:103], v[152:155], v[32:47]
    v_mfma_f32_32x32x16_bf16 v[48:63], v[96:99], v[156:159], v[48:63]
    v_mfma_f32_32x32x16_bf16 v[64:79], v[100:103], v[156:159], v[64:79]
    s_waitcnt vmcnt(26)
    ds_read_b64_tr_b16 v[96:97], v6 offset:8192
    ds_read_b64_tr_b16 v[98:99], v6 offset:9216
    ds_read_b64_tr_b16 v[100:101], v7 offset:8192
    ds_read_b64_tr_b16 v[102:103], v7 offset:9216
    s_waitcnt vmcnt(6)
    s_waitcnt lgkmcnt(8)
    v_mfma_f32_32x32x16_bf16 v[16:31], v[80:83], v[160:163], v[16:31]
    v_mfma_f32_32x32x16_bf16 v[32:47], v[84:87], v[160:163], v[32:47]
    v_mfma_f32_32x32x16_bf16 v[48:63], v[80:83], v[164:167], v[48:63]
    v_mfma_f32_32x32x16_bf16 v[64:79], v[84:87], v[164:167], v[64:79]
    s_waitcnt vmcnt(10)
    ds_read_b64_tr_b16 v[80:81], v6 offset:10240
    ds_read_b64_tr_b16 v[82:83], v6 offset:11264
    ds_read_b64_tr_b16 v[84:85], v7 offset:10240
    ds_read_b64_tr_b16 v[86:87], v7 offset:11264
    s_waitcnt vmcnt(4)
    s_waitcnt lgkmcnt(8)
    v_mfma_f32_32x32x16_bf16 v[16:31], v[88:91], v[168:171], v[16:31]
    v_mfma_f32_32x32x16_bf16 v[32:47], v[92:95], v[168:171], v[32:47]
    v_mfma_f32_32x32x16_bf16 v[48:63], v[88:91], v[172:175], v[48:63]
    v_mfma_f32_32x32x16_bf16 v[64:79], v[92:95], v[172:175], v[64:79]
    s_waitcnt vmcnt(2)
    s_waitcnt lgkmcnt(4)
    v_mfma_f32_32x32x16_bf16 v[16:31], v[96:99], v[176:179], v[16:31]
    v_mfma_f32_32x32x16_bf16 v[32:47], v[100:103], v[176:179], v[32:47]
    v_mfma_f32_32x32x16_bf16 v[48:63], v[96:99], v[180:183], v[48:63]
    v_mfma_f32_32x32x16_bf16 v[64:79], v[100:103], v[180:183], v[64:79]
    s_waitcnt vmcnt(0)
    s_waitcnt lgkmcnt(0)
    v_mfma_f32_32x32x16_bf16 v[16:31], v[80:83], v[184:187], v[16:31]
    v_mfma_f32_32x32x16_bf16 v[32:47], v[84:87], v[184:187], v[32:47]
    v_mfma_f32_32x32x16_bf16 v[48:63], v[80:83], v[188:191], v[48:63]
    v_mfma_f32_32x32x16_bf16 v[64:79], v[84:87], v[188:191], v[64:79]
    s_setprio 3
    v_mov_b32 v12, 0
    v_xor_b32 v80, 0, v9
    v_xor_b32 v81, 32, v9
    v_xor_b32 v82, 64, v9
    v_xor_b32 v83, 96, v9
    v_xor_b32 v84, 128, v9
    v_xor_b32 v85, 160, v9
    v_xor_b32 v86, 192, v9
    v_xor_b32 v87, 224, v9
    s_nop 1
    ds_write_b128 v80, v[16:19] offset:0
    ds_write_b128 v80, v[48:51] offset:8192
    ds_write_b128 v81, v[20:23] offset:0
    ds_write_b128 v81, v[52:55] offset:8192
    ds_write_b128 v82, v[24:27] offset:0
    ds_write_b128 v82, v[56:59] offset:8192
    ds_write_b128 v83, v[28:31] offset:0
    ds_write_b128 v83, v[60:63] offset:8192
    ds_write_b128 v84, v[32:35] offset:0
    ds_write_b128 v84, v[64:67] offset:8192
    ds_write_b128 v85, v[36:39] offset:0
    ds_write_b128 v85, v[68:71] offset:8192
    ds_write_b128 v86, v[40:43] offset:0
    ds_write_b128 v86, v[72:75] offset:8192
    ds_write_b128 v87, v[44:47] offset:0
    ds_write_b128 v87, v[76:79] offset:8192
    v_add_u32 v80, s37, v80
    v_add_u32 v81, s37, v81
    v_add_u32 v82, s37, v82
    v_add_u32 v83, s37, v83
    v_add_u32 v84, s37, v84
    v_add_u32 v85, s37, v85
    v_add_u32 v86, s37, v86
    v_add_u32 v87, s37, v87
    s_waitcnt lgkmcnt(0)
    s_mov_b64 exec, 1
    ds_add_u32 v3, v11 offset:4
    s_mov_b64 exec, -1
    s_waitcnt vmcnt(0)
    s_mov_b32 s62, 200000
LP_47:
    buffer_load_dword v12, v8, s[12:15], s30 offen sc1
    s_waitcnt vmcnt(0)
    v_cmp_ne_u32 vcc, s28, v12
    s_cbranch_vccz LPD_48
    s_sleep 4
    s_sub_u32 s62, s62, 1
    s_cbranch_scc0 LP_47
LPD_48:
L_46:
    s_mov_b32 s52, s38
    buffer_load_dwordx4 v[128:131], v2, s[12:15], s52 offen offset:0 sc1
    buffer_load_dwordx4 v[132:135], v2, s[12:15], s52 offen offset:2048 sc1
    s_add_u32 s52, s52, 4096
    buffer_load_dwordx4 v[136:139], v2, s[12:15], s52 offen offset:0 sc1
    buffer_load_dwordx4 v[140:143], v2, s[12:15], s52 offen offset:2048 sc1
    s_add_u32 s52, s52, 4096
    buffer_load_dwordx4 v[144:147], v2, s[12:15], s52 offen offset:0 sc1
    buffer_load_dwordx4 v[148:151], v2, s[12:15], s52 offen offset:2048 sc1
    s_add_u32 s52, s52, 4096
    buffer_load_dwordx4 v[152:155], v2, s[12:15], s52 offen offset:0 sc1
    buffer_load_dwordx4 v[156:159], v2, s[12:15], s52 offen offset:2048 sc1
    s_xor_b32 s52, s38, 1024
    buffer_load_dwordx4 v[160:163], v2, s[12:15], s52 offen offset:0 sc1
    buffer_load_dwordx4 v[164:167], v2, s[12:15], s52 offen offset:2048 sc1
    s_add_u32 s52, s52, 4096
    buffer_load_dwordx4 v[168:171], v2, s[12:15], s52 offen offset:0 sc1
    buffer_load_dwordx4 v[172:175], v2, s[12:15], s52 offen offset:2048 sc1
    s_add_u32 s52, s52, 4096
    buffer_load_dwordx4 v[176:179], v2, s[12:15], s52 offen offset:0 sc1
    buffer_load_dwordx4 v[180:183], v2, s[12:15], s52 offen offset:2048 sc1
    s_add_u32 s52, s52, 4096
    buffer_load_dwordx4 v[184:187], v2, s[12:15], s52 offen offset:0 sc1
    buffer_load_dwordx4 v[188:191], v2, s[12:15], s52 offen offset:2048 sc1
    s_waitcnt vmcnt(15)
    v_mfma_f32_32x32x16_bf16 v[16:31], v[192:195], v[128:131], 0
    v_mfma_f32_32x32x16_bf16 v[32:47], v[196:199], v[128:131], 0
    s_waitcnt vmcnt(14)
    v_mfma_f32_32x32x16_bf16 v[16:31], v[200:203], v[132:135], v[16:31]
    v_mfma_f32_32x32x16_bf16 v[32:47], v[204:207], v[132:135], v[32:47]
    s_waitcnt vmcnt(13)
    v_mfma_f32_32x32x16_bf16 v[16:31], v[208:211], v[136:139], v[16:31]
    v_mfma_f32_32x32x16_bf16 v[32:47], v[212:215], v[136:139], v[32:47]
    s_waitcnt vmcnt(12)
    v_mfma_f32_32x32x16_bf16 v[16:31], v[216:219], v[140:143], v[16:31]
    v_mfma_f32_32x32x16_bf16 v[32:47], v[220:223], v[140:143], v[32:47]
    s_waitcnt vmcnt(11)
    v_mfma_f32_32x32x16_bf16 v[16:31], v[224:227], v[144:147], v[16:31]
    v_mfma_f32_32x32x16_bf16 v[32:47], v[228:231], v[144:147], v[32:47]
    s_waitcnt vmcnt(10)
    v_mfma_f32_32x32x16_bf16 v[16:31], v[232:235], v[148:151], v[16:31]
    v_mfma_f32_32x32x16_bf16 v[32:47], v[236:239], v[148:151], v[32:47]
    s_waitcnt vmcnt(9)
    v_mfma_f32_32x32x16_bf16 v[16:31], v[240:243], v[152:155], v[16:31]
    v_mfma_f32_32x32x16_bf16 v[32:47], v[244:247], v[152:155], v[32:47]
    s_waitcnt vmcnt(8)
    v_mfma_f32_32x32x16_bf16 v[16:31], v[248:251], v[156:159], v[16:31]
    v_mfma_f32_32x32x16_bf16 v[32:47], v[252:255], v[156:159], v[32:47]
    s_waitcnt vmcnt(7)
    v_mfma_f32_32x32x16_bf16 v[48:63], v[192:195], v[160:163], 0
    v_mfma_f32_32x32x16_bf16 v[64:79], v[196:199], v[160:163], 0
    s_waitcnt vmcnt(6)
    v_mfma_f32_32x32x16_bf16 v[48:63], v[200:203], v[164:167], v[48:63]
    v_mfma_f32_32x32x16_bf16 v[64:79], v[204:207], v[164:167], v[64:79]
    s_waitcnt vmcnt(5)
    v_mfma_f32_32x32x16_bf16 v[48:63], v[208:211], v[168:171], v[48:63]
    v_mfma_f32_32x32x16_bf16 v[64:79], v[212:215], v[168:171], v[64:79]
    s_waitcnt vmcnt(4)
    v_mfma_f32_32x32x16_bf16 v[48:63], v[216:219], v[172:175], v[48:63]
    v_mfma_f32_32x32x16_bf16 v[64:79], v[220:223], v[172:175], v[64:79]
    s_waitcnt vmcnt(3)
    v_mfma_f32_32x32x16_bf16 v[48:63], v[224:227], v[176:179], v[48:63]
    v_mfma_f32_32x32x16_bf16 v[64:79], v[228:231], v[176:179], v[64:79]
    ds_write_b128 v80, v[16:19] offset:16384
    ds_write_b128 v81, v[20:23] offset:16384
    s_waitcnt vmcnt(2)
    v_mfma_f32_32x32x16_bf16 v[48:63], v[232:235], v[180:183], v[48:63]
    v_mfma_f32_32x32x16_bf16 v[64:79], v[236:239], v[180:183], v[64:79]
    ds_write_b128 v82, v[24:27] offset:16384
    ds_write_b128 v83, v[28:31] offset:16384
    s_waitcnt vmcnt(1)
    v_mfma_f32_32x32x16_bf16 v[48:63], v[240:243], v[184:187], v[48:63]
    v_mfma_f32_32x32x16_bf16 v[64:79], v[244:247], v[184:187], v[64:79]
    ds_write_b128 v84, v[32:35] offset:16384
    ds_write_b128 v85, v[36:39] offset:16384
    s_waitcnt vmcnt(0)
    v_mfma_f32_32x32x16_bf16 v[48:63], v[248:251], v[188:191], v[48:63]
    v_mfma_f32_32x32x16_bf16 v[64:79], v[252:255], v[188:191], v[64:79]
    ds_write_b128 v86, v[40:43] offset:16384
    ds_write_b128 v87, v[44:47] offset:16384
    v_xor_b32 v80, 0x2000, v80
    v_xor_b32 v81, 0x2000, v81
    v_xor_b32 v82, 0x2000, v82
    v_xor_b32 v83, 0x2000, v83
    v_xor_b32 v84, 0x2000, v84
    v_xor_b32 v85, 0x2000, v85
    v_xor_b32 v86, 0x2000, v86
    v_xor_b32 v87, 0x2000, v87
    s_nop 1
    ds_write_b128 v80, v[48:51] offset:16384
    ds_write_b128 v81, v[52:55] offset:16384
    ds_write_b128 v82, v[56:59] offset:16384
    ds_write_b128 v83, v[60:63] offset:16384
    ds_write_b128 v84, v[64:67] offset:16384
    ds_write_b128 v85, v[68:71] offset:16384
    ds_write_b128 v86, v[72:75] offset:16384
    ds_write_b128 v87, v[76:79] offset:16384
    s_waitcnt lgkmcnt(0)
    s_barrier
L_fin:
L_exit:
    s_endpgm
    .p2align 6
L_att:
    v_exp_f32 v32, v32
    v_exp_f32 v33, v33
    v_exp_f32 v34, v34
    v_exp_f32 v35, v35
    v_mfma_f32_32x32x16_bf16 v[176:191], v[236:239], v[244:247], v[176:191]
    global_load_dwordx4 v[228:231], v2, s[48:49] offset:2048 sc1
    global_load_dwordx4 v[232:235], v254, s[48:49] offset:2048 sc1
    global_load_dwordx4 v[236:239], v255, s[48:49] offset:2560 sc1
    s_add_u32 s60, s60, s42
    s_and_b32 s60, s60, 0x3ffff
    s_add_u32 s48, s16, s60
    s_addc_u32 s49, s17, 0
    v_exp_f32 v36, v36
    v_exp_f32 v37, v37
    v_exp_f32 v38, v38
    v_exp_f32 v39, v39
    v_cvt_pk_bf16_f32 v240, v32, v33
    v_cvt_pk_bf16_f32 v241, v34, v35
    v_cvt_pk_bf16_f32 v242, v36, v37
    v_cvt_pk_bf16_f32 v243, v38, v39
    v_mfma_f32_32x32x16_bf16 v[48:63], v[192:195], v[20:23], v[80:95]
    v_exp_f32 v40, v40
    v_exp_f32 v41, v41
    v_exp_f32 v42, v42
    v_exp_f32 v43, v43
    v_mfma_f32_32x32x16_bf16 v[128:143], v[196:199], v[240:243], v[128:143]
    v_exp_f32 v44, v44
    v_exp_f32 v45, v45
    v_exp_f32 v46, v46
    v_exp_f32 v47, v47
    v_cvt_pk_bf16_f32 v244, v40, v41
    v_cvt_pk_bf16_f32 v245, v42, v43
    v_cvt_pk_bf16_f32 v246, v44, v45
    v_cvt_pk_bf16_f32 v247, v46, v47
    v_exp_f32 v48, v48
    v_exp_f32 v49, v49
    v_exp_f32 v50, v50
    v_exp_f32 v51, v51
    v_mfma_f32_32x32x16_bf16 v[128:143], v[200:203], v[244:247], v[128:143]
    v_exp_f32 v52, v52
    v_exp_f32 v53, v53
    v_exp_f32 v54, v54
    v_exp_f32 v55, v55
    v_cvt_pk_bf16_f32 v240, v48, v49
    v_cvt_pk_bf16_f32 v241, v50, v51
    v_cvt_pk_bf16_f32 v242, v52, v53
    v_cvt_pk_bf16_f32 v243, v54, v55
    v_mfma_f32_32x32x16_bf16 v[32:47], v[192:195], v[24:27], v[96:111]
    v_exp_f32 v56, v56
    v_exp_f32 v57, v57
    v_exp_f32 v58, v58
    v_exp_f32 v59, v59
    v_mfma_f32_32x32x16_bf16 v[144:159], v[196:199], v[240:243], v[144:159]
    v_exp_f32 v60, v60
    v_exp_f32 v61, v61
    v_exp_f32 v62, v62
    v_exp_f32 v63, v63
    v_cvt_pk_bf16_f32 v244, v56, v57
    v_cvt_pk_bf16_f32 v245, v58, v59
    v_cvt_pk_bf16_f32 v246, v60, v61
    v_cvt_pk_bf16_f32 v247, v62, v63
    v_exp_f32 v32, v32
    v_exp_f32 v33, v33
    v_exp_f32 v34, v34
    v_exp_f32 v35, v35
    v_mfma_f32_32x32x16_bf16 v[144:159], v[200:203], v[244:247], v[144:159]
    v_exp_f32 v36, v36
    v_exp_f32 v37, v37
    v_exp_f32 v38, v38
    v_exp_f32 v39, v39
    v_cvt_pk_bf16_f32 v240, v32, v33
    v_cvt_pk_bf16_f32 v241, v34, v35
    v_cvt_pk_bf16_f32 v242, v36, v37
    v_cvt_pk_bf16_f32 v243, v38, v39
    v_mfma_f32_32x32x16_bf16 v[48:63], v[192:195], v[28:31], v[112:127]
    v_exp_f32 v40, v40
    v_exp_f32 v41, v41
    v_exp_f32 v42, v42
    v_exp_f32 v43, v43
    v_mfma_f32_32x32x16_bf16 v[160:175], v[196:199], v[240:243], v[160:175]
    v_exp_f32 v44, v44
    v_exp_f32 v45, v45
    v_exp_f32 v46, v46
    v_exp_f32 v47, v47
    v_cvt_pk_bf16_f32 v244, v40, v41
    v_cvt_pk_bf16_f32 v245, v42, v43
    v_cvt_pk_bf16_f32 v246, v44, v45
    v_cvt_pk_bf16_f32 v247, v46, v47
    v_exp_f32 v48, v48
    v_exp_f32 v49, v49
    v_exp_f32 v50, v50
    v_exp_f32 v51, v51
    v_mfma_f32_32x32x16_bf16 v[160:175], v[200:203], v[244:247], v[160:175]
    v_exp_f32 v52, v52
    v_exp_f32 v53, v53
    v_exp_f32 v54, v54
    v_exp_f32 v55, v55
    v_cvt_pk_bf16_f32 v240, v48, v49
    v_cvt_pk_bf16_f32 v241, v50, v51
    v_cvt_pk_bf16_f32 v242, v52, v53
    v_cvt_pk_bf16_f32 v243, v54, v55
    s_waitcnt vmcnt(6)
    v_mfma_f32_32x32x16_bf16 v[32:47], v[204:207], v[16:19], v[64:79]
    v_exp_f32 v56, v56
    v_exp_f32 v57, v57
    v_exp_f32 v58, v58
    v_exp_f32 v59, v59
    v_mfma_f32_32x32x16_bf16 v[176:191], v[196:199], v[240:243], v[176:191]
    v_exp_f32 v60, v60
    v_exp_f32 v61, v61
    v_exp_f32 v62, v62
    v_exp_f32 v63, v63
    v_cvt_pk_bf16_f32 v244, v56, v57
    v_cvt_pk_bf16_f32 v245, v58, v59
    v_cvt_pk_bf16_f32 v246, v60, v61
    v_cvt_pk_bf16_f32 v247, v62, v63
    v_exp_f32 v32, v32
    v_exp_f32 v33, v33
    v_exp_f32 v34, v34
    v_exp_f32 v35, v35
    v_mfma_f32_32x32x16_bf16 v[176:191], v[200:203], v[244:247], v[176:191]
    global_load_dwordx4 v[192:195], v2, s[48:49] offset:-4096 sc1
    global_load_dwordx4 v[196:199], v248, s[48:49] offset:-4096 sc1
    global_load_dwordx4 v[200:203], v249, s[48:49] offset:-3584 sc1
    v_exp_f32 v36, v36
    v_exp_f32 v37, v37
    v_exp_f32 v38, v38
    v_exp_f32 v39, v39
    v_cvt_pk_bf16_f32 v240, v32, v33
    v_cvt_pk_bf16_f32 v241, v34, v35
    v_cvt_pk_bf16_f32 v242, v36, v37
    v_cvt_pk_bf16_f32 v243, v38, v39
    v_mfma_f32_32x32x16_bf16 v[48:63], v[204:207], v[20:23], v[80:95]
    v_exp_f32 v40, v40
    v_exp_f32 v41, v41
    v_exp_f32 v42, v42
    v_exp_f32 v43, v43
    v_mfma_f32_32x32x16_bf16 v[128:143], v[208:211], v[240:243], v[128:143]
    v_exp_f32 v44, v44
    v_exp_f32 v45, v45
    v_exp_f32 v46, v46
    v_exp_f32 v47, v47
    v_cvt_pk_bf16_f32 v244, v40, v41
    v_cvt_pk_bf16_f32 v245, v42, v43
    v_cvt_pk_bf16_f32 v246, v44, v45
    v_cvt_pk_bf16_f32 v247, v46, v47
    v_exp_f32 v48, v48
    v_exp_f32 v49, v49
    v_exp_f32 v50, v50
    v_exp_f32 v51, v51
    v_mfma_f32_32x32x16_bf16 v[128:143], v[212:215], v[244:247], v[128:143]
    v_exp_f32 v52, v52
    v_exp_f32 v53, v53
    v_exp_f32 v54, v54
    v_exp_f32 v55, v55
    v_cvt_pk_bf16_f32 v240, v48, v49
    v_cvt_pk_bf16_f32 v241, v50, v51
    v_cvt_pk_bf16_f32 v242, v52, v53
    v_cvt_pk_bf16_f32 v243, v54, v55
    v_mfma_f32_32x32x16_bf16 v[32:47], v[204:207], v[24:27], v[96:111]
    v_exp_f32 v56, v56
    v_exp_f32 v57, v57
    v_exp_f32 v58, v58
    v_exp_f32 v59, v59
    v_mfma_f32_32x32x16_bf16 v[144:159], v[208:211], v[240:243], v[144:159]
    v_exp_f32 v60, v60
    v_exp_f32 v61, v61
    v_exp_f32 v62, v62
    v_exp_f32 v63, v63
    v_cvt_pk_bf16_f32 v244, v56, v57
    v_cvt_pk_bf16_f32 v245, v58, v59
    v_cvt_pk_bf16_f32 v246, v60, v61
    v_cvt_pk_bf16_f32 v247, v62, v63
    v_exp_f32 v32, v32
    v_exp_f32 v33, v33
    v_exp_f32 v34, v34
    v_exp_f32 v35, v35
    v_mfma_f32_32x32x16_bf16 v[144:159], v[212:215], v[244:247], v[144:159]
    v_exp_f32 v36, v36
    v_exp_f32 v37, v37
    v_exp_f32 v38, v38
    v_exp_f32 v39, v39
    v_cvt_pk_bf16_f32 v240, v32, v33
    v_cvt_pk_bf16_f32 v241, v34, v35
    v_cvt_pk_bf16_f32 v242, v36, v37
    v_cvt_pk_bf16_f32 v243, v38, v39
    v_mfma_f32_32x32x16_bf16 v[48:63], v[204:207], v[28:31], v[112:127]
    v_exp_f32 v40, v40
    v_exp_f32 v41, v41
    v_exp_f32 v42, v42
    v_exp_f32 v43, v43
    v_mfma_f32_32x32x16_bf16 v[160:175], v[208:211], v[240:243], v[160:175]
    v_exp_f32 v44, v44
    v_exp_f32 v45, v45
    v_exp_f32 v46, v46
    v_exp_f32 v47, v47
    v_cvt_pk_bf16_f32 v244, v40, v41
    v_cvt_pk_bf16_f32 v245, v42, v43
    v_cvt_pk_bf16_f32 v246, v44, v45
    v_cvt_pk_bf16_f32 v247, v46, v47
    v_exp_f32 v48, v48
    v_exp_f32 v49, v49
    v_exp_f32 v50, v50
    v_exp_f32 v51, v51
    v_mfma_f32_32x32x16_bf16 v[160:175], v[212:215], v[244:247], v[160:175]
    v_exp_f32 v52, v52
    v_exp_f32 v53, v53
    v_exp_f32 v54, v54
    v_exp_f32 v55, v55
    v_cvt_pk_bf16_f32 v240, v48, v49
    v_cvt_pk_bf16_f32 v241, v50, v51
    v_cvt_pk_bf16_f32 v242, v52, v53
    v_cvt_pk_bf16_f32 v243, v54, v55
    s_waitcnt vmcnt(6)
    v_mfma_f32_32x32x16_bf16 v[32:47], v[216:219], v[16:19], v[64:79]
    v_exp_f32 v56, v56
    v_exp_f32 v57, v57
    v_exp_f32 v58, v58
    v_exp_f32 v59, v59
    v_mfma_f32_32x32x16_bf16 v[176:191], v[208:211], v[240:243], v[176:191]
    v_exp_f32 v60, v60
    v_exp_f32 v61, v61
    v_exp_f32 v62, v62
    v_exp_f32 v63, v63
    v_cvt_pk_bf16_f32 v244, v56, v57
    v_cvt_pk_bf16_f32 v245, v58, v59
    v_cvt_pk_bf16_f32 v246, v60, v61
    v_cvt_pk_bf16_f32 v247, v62, v63
    v_exp_f32 v32, v32
    v_exp_f32 v33, v33
    v_exp_f32 v34, v34
    v_exp_f32 v35, v35
    v_mfma_f32_32x32x16_bf16 v[176:191], v[212:215], v[244:247], v[176:191]
    global_load_dwordx4 v[204:207], v2, s[48:49] offset:-2048 sc1
    global_load_dwordx4 v[208:211], v250, s[48:49] offset:-2048 sc1
    global_load_dwordx4 v[212:215], v251, s[48:49] offset:-1536 sc1
    v_exp_f32 v36, v36
    v_exp_f32 v37, v37
    v_exp_f32 v38, v38
    v_exp_f32 v39, v39
    v_cvt_pk_bf16_f32 v240, v32, v33
    v_cvt_pk_bf16_f32 v241, v34, v35
    v_cvt_pk_bf16_f32 v242, v36, v37
    v_cvt_pk_bf16_f32 v243, v38, v39
    v_mfma_f32_32x32x16_bf16 v[48:63], v[216:219], v[20:23], v[80:95]
    v_exp_f32 v40, v40
    v_exp_f32 v41, v41
    v_exp_f32 v42, v42
    v_exp_f32 v43, v43
    v_mfma_f32_32x32x16_bf16 v[128:143], v[220:223], v[240:243], v[128:143]
    v_exp_f32 v44, v44
    v_exp_f32 v45, v45
    v_exp_f32 v46, v46
    v_exp_f32 v47, v47
    v_cvt_pk_bf16_f32 v244, v40, v41
    v_cvt_pk_bf16_f32 v245, v42, v43
    v_cvt_pk_bf16_f32 v246, v44, v45
    v_cvt_pk_bf16_f32 v247, v46, v47
    v_exp_f32 v48, v48
    v_exp_f32 v49, v49
    v_exp_f32 v50, v50
    v_exp_f32 v51, v51
    v_mfma_f32_32x32x16_bf16 v[128:143], v[224:227], v[244:247], v[128:143]
    v_exp_f32 v52, v52
    v_exp_f32 v53, v53
    v_exp_f32 v54, v54
    v_exp_f32 v55, v55
    v_cvt_pk_bf16_f32 v240, v48, v49
    v_cvt_pk_bf16_f32 v241, v50, v51
    v_cvt_pk_bf16_f32 v242, v52, v53
    v_cvt_pk_bf16_f32 v243, v54, v55
    v_mfma_f32_32x32x16_bf16 v[32:47], v[216:219], v[24:27], v[96:111]
    v_exp_f32 v56, v56
    v_exp_f32 v57, v57
    v_exp_f32 v58, v58
    v_exp_f32 v59, v59
    v_mfma_f32_32x32x16_bf16 v[144:159], v[220:223], v[240:243], v[144:159]
    v_exp_f32 v60, v60
    v_exp_f32 v61, v61
    v_exp_f32 v62, v62
    v_exp_f32 v63, v63
    v_cvt_pk_bf16_f32 v244, v56, v57
    v_cvt_pk_bf16_f32 v245, v58, v59
    v_cvt_pk_bf16_f32 v246, v60, v61
    v_cvt_pk_bf16_f32 v247, v62, v63
    v_exp_f32 v32, v32
    v_exp_f32 v33, v33
    v_exp_f32 v34, v34
    v_exp_f32 v35, v35
    v_mfma_f32_32x32x16_bf16 v[144:159], v[224:227], v[244:247], v[144:159]
    v_exp_f32 v36, v36
    v_exp_f32 v37, v37
    v_exp_f32 v38, v38
    v_exp_f32 v39, v39
    v_cvt_pk_bf16_f32 v240, v32, v33
    v_cvt_pk_bf16_f32 v241, v34, v35
    v_cvt_pk_bf16_f32 v242, v36, v37
    v_cvt_pk_bf16_f32 v243, v38, v39
    v_mfma_f32_32x32x16_bf16 v[48:63], v[216:219], v[28:31], v[112:127]
    v_exp_f32 v40, v40
    v_exp_f32 v41, v41
    v_exp_f32 v42, v42
    v_exp_f32 v43, v43
    v_mfma_f32_32x32x16_bf16 v[160:175], v[220:223], v[240:243], v[160:175]
    v_exp_f32 v44, v44
    v_exp_f32 v45, v45
    v_exp_f32 v46, v46
    v_exp_f32 v47, v47
    v_cvt_pk_bf16_f32 v244, v40, v41
    v_cvt_pk_bf16_f32 v245, v42, v43
    v_cvt_pk_bf16_f32 v246, v44, v45
    v_cvt_pk_bf16_f32 v247, v46, v47
    v_exp_f32 v48, v48
    v_exp_f32 v49, v49
    v_exp_f32 v50, v50
    v_exp_f32 v51, v51
    v_mfma_f32_32x32x16_bf16 v[160:175], v[224:227], v[244:247], v[160:175]
    v_exp_f32 v52, v52
    v_exp_f32 v53, v53
    v_exp_f32 v54, v54
    v_exp_f32 v55, v55
    v_cvt_pk_bf16_f32 v240, v48, v49
    v_cvt_pk_bf16_f32 v241, v50, v51
    v_cvt_pk_bf16_f32 v242, v52, v53
    v_cvt_pk_bf16_f32 v243, v54, v55
    s_waitcnt vmcnt(6)
    v_mfma_f32_32x32x16_bf16 v[32:47], v[228:231], v[16:19], v[64:79]
    v_exp_f32 v56, v56
    v_exp_f32 v57, v57
    v_exp_f32 v58, v58
    v_exp_f32 v59, v59
    v_mfma_f32_32x32x16_bf16 v[176:191], v[220:223], v[240:243], v[176:191]
    v_exp_f32 v60, v60
    v_exp_f32 v61, v61
    v_exp_f32 v62, v62
    v_exp_f32 v63, v63
    v_cvt_pk_bf16_f32 v244, v56, v57
    v_cvt_pk_bf16_f32 v245, v58, v59
    v_cvt_pk_bf16_f32 v246, v60, v61
    v_cvt_pk_bf16_f32 v247, v62, v63
    v_exp_f32 v32, v32
    v_exp_f32 v33, v33
    v_exp_f32 v34, v34
    v_exp_f32 v35, v35
    v_mfma_f32_32x32x16_bf16 v[176:191], v[224:227], v[244:247], v[176:191]
    global_load_dwordx4 v[216:219], v2, s[48:49] offset:0 sc1
    global_load_dwordx4 v[220:223], v252, s[48:49] offset:0 sc1
    global_load_dwordx4 v[224:227], v253, s[48:49] offset:512 sc1
    v_exp_f32 v36, v36
    v_exp_f32 v37, v37
    v_exp_f32 v38, v38
    v_exp_f32 v39, v39
    v_cvt_pk_bf16_f32 v240, v32, v33
    v_cvt_pk_bf16_f32 v241, v34, v35
    v_cvt_pk_bf16_f32 v242, v36, v37
    v_cvt_pk_bf16_f32 v243, v38, v39
    v_mfma_f32_32x32x16_bf16 v[48:63], v[228:231], v[20:23], v[80:95]
    v_exp_f32 v40, v40
    v_exp_f32 v41, v41
    v_exp_f32 v42, v42
    v_exp_f32 v43, v43
    v_mfma_f32_32x32x16_bf16 v[128:143], v[232:235], v[240:243], v[128:143]
    v_exp_f32 v44, v44
    v_exp_f32 v45, v45
    v_exp_f32 v46, v46
    v_exp_f32 v47, v47
    v_cvt_pk_bf16_f32 v244, v40, v41
    v_cvt_pk_bf16_f32 v245, v42, v43
    v_cvt_pk_bf16_f32 v246, v44, v45
    v_cvt_pk_bf16_f32 v247, v46, v47
    v_exp_f32 v48, v48
    v_exp_f32 v49, v49
    v_exp_f32 v50, v50
    v_exp_f32 v51, v51
    v_mfma_f32_32x32x16_bf16 v[128:143], v[236:239], v[244:247], v[128:143]
    s_sub_u32 s59, s59, 1
    v_exp_f32 v52, v52
    v_exp_f32 v53, v53
    v_exp_f32 v54, v54
    v_exp_f32 v55, v55
    v_cvt_pk_bf16_f32 v240, v48, v49
    v_cvt_pk_bf16_f32 v241, v50, v51
    v_cvt_pk_bf16_f32 v242, v52, v53
    v_cvt_pk_bf16_f32 v243, v54, v55
    v_mfma_f32_32x32x16_bf16 v[32:47], v[228:231], v[24:27], v[96:111]
    v_exp_f32 v56, v56
    v_exp_f32 v57, v57
    v_exp_f32 v58, v58
    v_exp_f32 v59, v59
    v_mfma_f32_32x32x16_bf16 v[144:159], v[232:235], v[240:243], v[144:159]
    v_exp_f32 v60, v60
    v_exp_f32 v61, v61
    v_exp_f32 v62, v62
    v_exp_f32 v63, v63
    v_cvt_pk_bf16_f32 v244, v56, v57
    v_cvt_pk_bf16_f32 v245, v58, v59
    v_cvt_pk_bf16_f32 v246, v60, v61
    v_cvt_pk_bf16_f32 v247, v62, v63
    v_exp_f32 v32, v32
    v_exp_f32 v33, v33
    v_exp_f32 v34, v34
    v_exp_f32 v35, v35
    v_mfma_f32_32x32x16_bf16 v[144:159], v[236:239], v[244:247], v[144:159]
    v_exp_f32 v36, v36
    v_exp_f32 v37, v37
    v_exp_f32 v38, v38
    v_exp_f32 v39, v39
    v_cvt_pk_bf16_f32 v240, v32, v33
    v_cvt_pk_bf16_f32 v241, v34, v35
    v_cvt_pk_bf16_f32 v242, v36, v37
    v_cvt_pk_bf16_f32 v243, v38, v39
    v_mfma_f32_32x32x16_bf16 v[48:63], v[228:231], v[28:31], v[112:127]
    v_exp_f32 v40, v40
    v_exp_f32 v41, v41
    v_exp_f32 v42, v42
    v_exp_f32 v43, v43
    v_mfma_f32_32x32x16_bf16 v[160:175], v[232:235], v[240:243], v[160:175]
    v_exp_f32 v44, v44
    v_exp_f32 v45, v45
    v_exp_f32 v46, v46
    v_exp_f32 v47, v47
    v_cvt_pk_bf16_f32 v244, v40, v41
    v_cvt_pk_bf16_f32 v245, v42, v43
    v_cvt_pk_bf16_f32 v246, v44, v45
    v_cvt_pk_bf16_f32 v247, v46, v47
    v_exp_f32 v48, v48
    v_exp_f32 v49, v49
    v_exp_f32 v50, v50
    v_exp_f32 v51, v51
    v_mfma_f32_32x32x16_bf16 v[160:175], v[236:239], v[244:247], v[160:175]
    v_exp_f32 v52, v52
    v_exp_f32 v53, v53
    v_exp_f32 v54, v54
    v_exp_f32 v55, v55
    v_cvt_pk_bf16_f32 v240, v48, v49
    v_cvt_pk_bf16_f32 v241, v50, v51
    v_cvt_pk_bf16_f32 v242, v52, v53
    v_cvt_pk_bf16_f32 v243, v54, v55
    s_waitcnt vmcnt(6)
    v_mfma_f32_32x32x16_bf16 v[32:47], v[192:195], v[16:19], v[64:79]
    v_exp_f32 v56, v56
    v_exp_f32 v57, v57
    v_exp_f32 v58, v58
    v_exp_f32 v59, v59
    v_mfma_f32_32x32x16_bf16 v[176:191], v[232:235], v[240:243], v[176:191]
    v_exp_f32 v60, v60
    v_exp_f32 v61, v61
    v_exp_f32 v62, v62
    v_exp_f32 v63, v63
    v_cvt_pk_bf16_f32 v244, v56, v57
    v_cvt_pk_bf16_f32 v245, v58, v59
    v_cvt_pk_bf16_f32 v246, v60, v61
    v_cvt_pk_bf16_f32 v247, v62, v63
    s_cbranch_scc0 L_att
    s_setpc_b64 s[94:95]
L_slow:
    s_waitcnt vmcnt(0)
    s_mov_b32 s60, 0
    s_mov_b32 s59, 64
    v_mov_b32 v13, 0xff800000
    v_mov_b32 v14, 0xff800000
L_slow_loop:
    s_add_u32 s48, s16, s60
    s_addc_u32 s49, s17, 0
    global_load_dwordx4 v[192:195], v2, s[48:49] offset:-4096 sc1
    s_add_u32 s60, s60, 2048
    s_and_b32 s52, s60, 8192
    s_add_u32 s60, s60, s52
    s_waitcnt vmcnt(0)
    v_mfma_f32_32x32x16_bf16 v[32:47], v[192:195], v[16:19], 0
    v_mfma_f32_32x32x16_bf16 v[48:63], v[192:195], v[20:23], 0
    s_nop 15
    s_nop 3
    v_max3_f32 v13, v13, v32, v33
    v_max3_f32 v13, v13, v34, v35
    v_max3_f32 v13, v13, v36, v37
    v_max3_f32 v13, v13, v38, v39
    v_max3_f32 v13, v13, v40, v41
    v_max3_f32 v13, v13, v42, v43
    v_max3_f32 v13, v13, v44, v45
    v_max3_f32 v13, v13, v46, v47
    v_max3_f32 v14, v14, v48, v49
    v_max3_f32 v14, v14, v50, v51
    v_max3_f32 v14, v14, v52, v53
    v_max3_f32 v14, v14, v54, v55
    v_max3_f32 v14, v14, v56, v57
    v_max3_f32 v14, v14, v58, v59
    v_max3_f32 v14, v14, v60, v61
    v_max3_f32 v14, v14, v62, v63
    s_sub_u32 s59, s59, 1
    s_cmp_lg_u32 s59, 0
    s_cbranch_scc1 L_slow_loop
    s_mov_b32 s60, 0
    s_mov_b64 s[48:49], s[16:17]
    s_mov_b32 s42, 16384
    s_mov_b32 s59, 15
    v_mov_b32 v236, 0
    v_mov_b32 v244, 0
    v_mov_b32 v237, 0
    v_mov_b32 v245, 0
    v_mov_b32 v238, 0
    v_mov_b32 v246, 0
    v_mov_b32 v239, 0
    v_mov_b32 v247, 0
    global_load_dwordx4 v[192:195], v2, s[48:49] offset:-4096 sc1
    global_load_dwordx4 v[196:199], v248, s[48:49] offset:-4096 sc1
    global_load_dwordx4 v[200:203], v249, s[48:49] offset:-3584 sc1
    global_load_dwordx4 v[204:207], v2, s[48:49] offset:-2048 sc1
    global_load_dwordx4 v[208:211], v250, s[48:49] offset:-2048 sc1
    global_load_dwordx4 v[212:215], v251, s[48:49] offset:-1536 sc1
    global_load_dwordx4 v[216:219], v2, s[48:49] offset:0 sc1
    global_load_dwordx4 v[220:223], v252, s[48:49] offset:0 sc1
    global_load_dwordx4 v[224:227], v253, s[48:49] offset:512 sc1
    v_mov_b64 v[128:129], 0
    v_mov_b64 v[130:131], 0
    v_mov_b64 v[132:133], 0
    v_mov_b64 v[134:135], 0
    v_mov_b64 v[136:137], 0
    v_mov_b64 v[138:139], 0
    v_mov_b64 v[140:141], 0
    v_mov_b64 v[142:143], 0
    v_mov_b64 v[144:145], 0
    v_mov_b64 v[146:147], 0
    v_mov_b64 v[148:149], 0
    v_mov_b64 v[150:151], 0
    v_mov_b64 v[152:153], 0
    v_mov_b64 v[154:155], 0
    v_mov_b64 v[156:157], 0
    v_mov_b64 v[158:159], 0
    v_mov_b32 v64, v13
    v_mov_b32 v80, v14
    s_nop 1
    v_permlane32_swap_b32 v64, v13
    v_permlane32_swap_b32 v80, v14
    s_nop 1
    v_max_f32 v13, v13, v64
    v_max_f32 v14, v14, v80
    v_sub_f32 v64, 0, v13
    v_sub_f32 v65, 0, v13
    v_sub_f32 v80, 0, v14
    v_sub_f32 v81, 0, v14
    v_mov_b64 v[66:67], v[64:65]
    v_mov_b64 v[68:69], v[64:65]
    v_mov_b64 v[70:71], v[64:65]
    v_mov_b64 v[72:73], v[64:65]
    v_mov_b64 v[74:75], v[64:65]
    v_mov_b64 v[76:77], v[64:65]
    v_mov_b64 v[78:79], v[64:65]
    v_mov_b64 v[82:83], v[80:81]
    v_mov_b64 v[84:85], v[80:81]
    v_mov_b64 v[86:87], v[80:81]
    v_mov_b64 v[88:89], v[80:81]
    v_mov_b64 v[90:91], v[80:81]
    v_mov_b64 v[92:93], v[80:81]
    v_mov_b64 v[94:95], v[80:81]
    s_waitcnt vmcnt(6)
    v_mfma_f32_32x32x16_bf16 v[32:47], v[192:195], v[16:19], v[64:79]
    s_nop 11
    s_call_b64 s[94:95], L_att
    s_nop 15
    s_branch L_norm
L_codeend:
.section .rodata,"a"
.p2align 6
.amdhsa_kernel recurrent_scan__softmax_full_mha__dense_activation_relu__prompt_kernel
  .amdhsa_next_free_vgpr 256
  .amdhsa_next_free_sgpr 102
  .amdhsa_accum_offset 256
  .amdhsa_group_segment_fixed_size 0
  .amdhsa_kernarg_size 72
  .amdhsa_user_sgpr_count 2
  .amdhsa_user_sgpr_kernarg_segment_ptr 1
  .amdhsa_system_sgpr_workgroup_id_x 1
.end_amdhsa_kernel
```
